```python
import torch

def _softmax(x, axis=-1):
    return torch.softmax(x, dim=axis)
def _gelu(x):
    return torch.nn.functional.gelu(x, approximate="tanh")
def _silu(x):
    return torch.nn.functional.silu(x)
def _sigmoid(x):
    return torch.sigmoid(x)
def _layernorm(x, axis=-1, eps=1e-5):
    m = x.mean(dim=axis, keepdim=True)
    v = x.var(dim=axis, keepdim=True, unbiased=False)
    return (x - m) / torch.sqrt(v + eps)
def _scatter_add(tgt, idx, src, axis=0):
    return tgt.clone().index_add_(axis, idx, src)
def _segment_sum(src, seg, n):
    out = torch.zeros((n,) + src.shape[1:], dtype=src.dtype)
    return out.index_add_(0, seg, src)
def _pad(x, pw):
    flat = tuple(v for pair in reversed(pw) for v in pair)
    return torch.nn.functional.pad(x, flat)

kernel_name = 'parallel_sum__mha_block_cached__glu_gated_reglu__decode'

def setup_inputs():

    _w = (lambda a: (lambda t: t.to(torch.bfloat16) if t.is_floating_point() else t)(torch.as_tensor(a)))
    def _A_setup():
        B, Sq, D = 1, 1, 576
        H, Sk, Dh = 32, 8192, 128
        return {
            "x": _w((lambda *s: torch.randn(*s, dtype=torch.bfloat16) * 0.05)(B, Sq, D)),
            "k_cache": _w((lambda *s: torch.randn(*s, dtype=torch.bfloat16) * 1.6)(B, H, Sk, Dh)),
            "v_cache": _w((lambda *s: torch.randn(*s, dtype=torch.bfloat16) * 0.8)(B, H, Sk, Dh)),
            "wq": _w((lambda *s: torch.randn(*s, dtype=torch.bfloat16) * 1.6)(D, H * Dh) * (D ** -0.5)),
            "wo": _w((lambda *s: torch.randn(*s, dtype=torch.bfloat16) * 0.8)(H * Dh, D) * ((H * Dh) ** -0.5)),
        }
    _A_in = _A_setup()

    def _B_setup():
        B, S, D, F = 1, 1, 576, 4608
        return {
            "x": _w((lambda *s: torch.randn(*s, dtype=torch.bfloat16) * 0.05)(B, S, D)),
            "W_gate": _w((lambda *s: torch.randn(*s, dtype=torch.bfloat16) * 0.4)(D, F) * (2.0 / D) ** 0.5),
            "W_up": _w((lambda *s: torch.randn(*s, dtype=torch.bfloat16) * 0.4)(D, F) * (2.0 / D) ** 0.5),
            "W_down": _w((lambda *s: torch.randn(*s, dtype=torch.bfloat16) * 0.4)(F, D) * (1.0 / F) ** 0.5),
        }
    _B_in = _B_setup()

    return {
        "A_x": _A_in["x"],
        "A_k_cache": _A_in["k_cache"],
        "A_v_cache": _A_in["v_cache"],
        "A_wq": _A_in["wq"],
        "A_wo": _A_in["wo"],
        "B_x": _B_in["x"],
        "B_W_gate": _B_in["W_gate"],
        "B_W_up": _B_in["W_up"],
        "B_W_down": _B_in["W_down"],
    }

def reference(A_x, A_k_cache, A_v_cache, A_wq, A_wo, B_x, B_W_gate, B_W_up, B_W_down):
    def _A_ref(x, k_cache, v_cache, wq, wo):
        B, Sq, D = x.shape
        H, Dh = 32, 128
        q = (lambda x, *d: x.permute(*d))((x @ wq).reshape(B, Sq, H, Dh), 0, 2, 1, 3)
        scores = torch.einsum("bhqd,bhkd->bhqk", q, k_cache) * (Dh ** -0.5)
        p = _softmax(scores, axis=-1)
        o = torch.einsum("bhqk,bhkd->bhqd", p, v_cache)
        return (lambda x, *d: x.permute(*d))(o, 0, 2, 1, 3).reshape(B, Sq, H * Dh) @ wo

    def _B_ref(x, W_gate, W_up, W_down):
        gate = torch.einsum("bsd,df->bsf", x, W_gate)
        up = torch.einsum("bsd,df->bsf", x, W_up)
        gate = gate * (lambda x, dt: x.to(dt))(gate > 0, gate.dtype)
        h = gate * up
        return torch.einsum("bsf,fd->bsd", h, W_down)

    x = A_x
    xn = _layernorm(x, axis=-1)
    return x + _A_ref(xn, A_k_cache, A_v_cache, A_wq, A_wo) + _B_ref(xn, B_W_gate, B_W_up, B_W_down)
```

```asm
; @launch grid=(256,1,1) block=(640,1,1) lds=57344
.amdgcn_target "amdgcn-amd-amdhsa--gfx950"
.text
.globl parallel_sum__mha_block_cached__glu_gated_reglu__decode_kernel
.p2align 8
.type parallel_sum__mha_block_cached__glu_gated_reglu__decode_kernel,@function
parallel_sum__mha_block_cached__glu_gated_reglu__decode_kernel:
    s_cmp_ge_u32 s2, 0x100
    s_cbranch_scc1 L_end
    s_load_dwordx16 s[4:19], s[0:1], 0
    s_load_dwordx8 s[20:27], s[0:1], 64
    s_cmp_ge_u32 s2, 32
    s_cbranch_scc1 L_nopref_1
    s_getpc_b64 s[28:29]
L_pc:
    s_mov_b32 s30, L_end-L_pc+4
    s_mov_b32 s31, 0x20000
    v_lshlrev_b32 v1, 7, v0
    buffer_load_dword v167, v1, s[28:31], 0 offen
L_nopref_1:
    v_lshrrev_b32 v44, 6, v0
    v_and_b32 v0, 63, v0
    v_readfirstlane_b32 s3, v44
    s_and_b32 s64, s2, 7
    s_lshr_b32 s65, s2, 3
    s_and_b32 s72, s65, 3
    s_lshr_b32 s67, s65, 2
    s_lshl_b32 s66, s64, 2
    s_add_u32 s66, s66, s72
    v_lshlrev_b32 v1, 4, v0
    v_and_b32 v45, 15, v0
    v_lshrrev_b32 v46, 4, v0
    s_cmp_lt_u32 s3, 8
    s_cbranch_scc1 L_att
    s_cmp_eq_u32 s3, 9
    s_cbranch_scc1 L_auxb
    s_setprio 3
    v_lshrrev_b32 v32, 3, v45
    v_lshl_add_u32 v32, v32, 2, v46
    v_and_b32 v33, 7, v45
    v_lshlrev_b32 v33, 4, v33
    v_mul_u32_u24 v4, 8192, v32
    v_add_u32 v4, v4, v33
    v_lshlrev_b32 v47, 1, v0
    s_mul_i32 s68, s67, 589824
    s_lshl_b32 s73, s66, 8
    s_add_u32 s68, s68, s73
    s_waitcnt lgkmcnt(0)
    s_mov_b32 s28, s4
    s_mov_b32 s29, s5
    s_mov_b32 s30, 1152
    s_mov_b32 s31, 0x20000
    buffer_load_dwordx4 v[24:27], v1, s[28:31], 0 offen
    buffer_load_ushort v28, v47, s[28:31], 0 offen offset:1024
    s_mov_b32 s40, s10
    s_mov_b32 s41, s11
    s_mov_b32 s42, 4718592
    s_mov_b32 s43, 0x20000
    buffer_load_dwordx4 v[48:51], v4, s[40:43], s68 offen offset:0 nt
    buffer_load_dwordx4 v[52:55], v4, s[40:43], s68 offen offset:128 nt
    s_add_u32 s68, s68, 65536
    buffer_load_dwordx4 v[56:59], v4, s[40:43], s68 offen offset:0 nt
    buffer_load_dwordx4 v[60:63], v4, s[40:43], s68 offen offset:128 nt
    s_add_u32 s68, s68, 65536
    buffer_load_dwordx4 v[64:67], v4, s[40:43], s68 offen offset:0 nt
    buffer_load_dwordx4 v[68:71], v4, s[40:43], s68 offen offset:128 nt
    s_add_u32 s68, s68, 65536
    buffer_load_dwordx4 v[72:75], v4, s[40:43], s68 offen offset:0 nt
    buffer_load_dwordx4 v[76:79], v4, s[40:43], s68 offen offset:128 nt
    s_add_u32 s68, s68, 65536
    buffer_load_dwordx4 v[80:83], v4, s[40:43], s68 offen offset:0 nt
    buffer_load_dwordx4 v[84:87], v4, s[40:43], s68 offen offset:128 nt
    s_add_u32 s68, s68, 65536
    buffer_load_dwordx4 v[88:91], v4, s[40:43], s68 offen offset:0 nt
    buffer_load_dwordx4 v[92:95], v4, s[40:43], s68 offen offset:128 nt
    s_add_u32 s68, s68, 65536
    buffer_load_dwordx4 v[96:99], v4, s[40:43], s68 offen offset:0 nt
    buffer_load_dwordx4 v[100:103], v4, s[40:43], s68 offen offset:128 nt
    s_add_u32 s68, s68, 65536
    buffer_load_dwordx4 v[104:107], v4, s[40:43], s68 offen offset:0 nt
    buffer_load_dwordx4 v[108:111], v4, s[40:43], s68 offen offset:128 nt
    s_add_u32 s68, s68, 65536
    buffer_load_dwordx4 v[112:115], v4, s[40:43], s68 offen offset:0 nt
    buffer_load_dwordx4 v[116:119], v4, s[40:43], s68 offen offset:128 nt
    v_mov_b32 v36, 0
    v_mov_b32 v37, 0
    v_mov_b32 v38, 0
    v_mov_b32 v39, 0
    ds_write_b128 v36, v[36:39] offset:1600
    ds_write_b128 v36, v[36:39] offset:1616
    s_waitcnt lgkmcnt(0)
    s_barrier
    s_load_dword s14, s[26:27], 0
    s_load_dword s15, s[26:27], 1040384
    v_mul_u32_u24 v3, 1152, v32
    v_add_u32 v3, v3, v33
    s_mov_b32 s60, s26
    s_mov_b32 s61, s27
    s_mov_b32 s62, 268435456
    s_mov_b32 s63, 0x20000
    s_mov_b32 s44, s12
    s_mov_b32 s45, s13
    s_mov_b32 s46, 4718592
    s_mov_b32 s47, 0x20000
    s_mov_b32 s48, s20
    s_mov_b32 s49, s21
    s_mov_b32 s50, 5308416
    s_mov_b32 s51, 0x20000
    s_mov_b32 s52, s22
    s_mov_b32 s53, s23
    s_mov_b32 s54, 1152
    s_mov_b32 s55, 0x20000
    v_lshrrev_b32 v32, 3, v45
    v_mul_u32_u24 v32, 0x202, v32
    v_add_u32 v32, 0x100, v32
    v_lshlrev_b32 v33, 16, v32
    v_or_b32 v33, 0xc0c, v33
    v_or_b32 v32, 0xc0c0000, v32
    v_and_b32 v34, 1, v45
    v_cmp_eq_u32 vcc, 1, v34
    s_nop 1
    v_cndmask_b32 v32, v32, v33, vcc
    v_bfe_u32 v34, v45, 1, 2
    v_mov_b32 v33, 0xc0c0c0c
    v_cmp_eq_u32 vcc, 0, v34
    s_nop 1
    v_cndmask_b32 v8, v33, v32, vcc
    v_cmp_eq_u32 vcc, 1, v34
    s_nop 1
    v_cndmask_b32 v9, v33, v32, vcc
    v_cmp_eq_u32 vcc, 2, v34
    s_nop 1
    v_cndmask_b32 v10, v33, v32, vcc
    v_cmp_eq_u32 vcc, 3, v34
    s_nop 1
    v_cndmask_b32 v11, v33, v32, vcc
    v_lshrrev_b32 v16, 3, v0
    v_lshlrev_b32 v16, 4, v16
    v_and_b32 v17, 3, v0
    v_lshl_add_u32 v16, v17, 2, v16
    v_bfe_u32 v17, v0, 2, 1
    v_lshl_add_u32 v16, v17, 1, v16
    v_lshlrev_b32 v18, 2, v46
    v_lshl_add_u32 v18, v45, 4, v18
    s_mul_i32 s72, s67, 144
    v_add_u32 v17, s72, v18
    v_mov_b32 v18, 0
    v_mov_b32 v19, 1
    s_waitcnt vmcnt(18)
    v_lshlrev_b32 v32, 16, v24
    v_and_b32 v33, 0xffff0000, v24
    v_lshlrev_b32 v34, 16, v25
    v_and_b32 v35, 0xffff0000, v25
    v_lshlrev_b32 v36, 16, v26
    v_and_b32 v37, 0xffff0000, v26
    v_lshlrev_b32 v38, 16, v27
    v_and_b32 v39, 0xffff0000, v27
    v_lshlrev_b32 v44, 16, v28
    v_add_f32 v42, v32, v33
    v_add_f32 v43, v34, v35
    v_add_f32 v40, v36, v37
    v_add_f32 v41, v38, v39
    v_add_f32 v42, v42, v43
    v_add_f32 v40, v40, v41
    v_add_f32 v42, v42, v44
    v_add_f32 v42, v42, v40
    s_nop 1
    v_add_f32_dpp v42, v42, v42 row_ror:8 row_mask:0xf bank_mask:0xf
    s_nop 1
    v_add_f32_dpp v42, v42, v42 row_half_mirror row_mask:0xf bank_mask:0xf
    s_nop 1
    v_add_f32_dpp v42, v42, v42 quad_perm:[2,3,0,1] row_mask:0xf bank_mask:0xf
    s_nop 1
    v_add_f32_dpp v42, v42, v42 quad_perm:[1,0,3,2] row_mask:0xf bank_mask:0xf
    v_mov_b32 v43, v42
    s_nop 1
    v_permlane16_swap_b32 v42, v43
    v_add_f32 v42, v42, v43
    v_mov_b32 v43, v42
    s_nop 1
    v_permlane32_swap_b32 v42, v43
    v_add_f32 v42, v42, v43
    v_mul_f32 v47, 0x3ae38e39, v42
    v_sub_f32 v32, v32, v47
    v_sub_f32 v33, v33, v47
    v_sub_f32 v34, v34, v47
    v_sub_f32 v35, v35, v47
    v_sub_f32 v36, v36, v47
    v_sub_f32 v37, v37, v47
    v_sub_f32 v38, v38, v47
    v_sub_f32 v39, v39, v47
    v_sub_f32 v44, v44, v47
    v_mul_f32 v42, v32, v32
    v_mul_f32 v43, v33, v33
    v_fmac_f32 v42, v34, v34
    v_fmac_f32 v43, v35, v35
    v_fmac_f32 v42, v36, v36
    v_fmac_f32 v43, v37, v37
    v_fmac_f32 v42, v38, v38
    v_fmac_f32 v43, v39, v39
    v_fmac_f32 v42, v44, v44
    v_add_f32 v42, v42, v43
    s_nop 1
    v_add_f32_dpp v42, v42, v42 row_ror:8 row_mask:0xf bank_mask:0xf
    s_nop 1
    v_add_f32_dpp v42, v42, v42 row_half_mirror row_mask:0xf bank_mask:0xf
    s_nop 1
    v_add_f32_dpp v42, v42, v42 quad_perm:[2,3,0,1] row_mask:0xf bank_mask:0xf
    s_nop 1
    v_add_f32_dpp v42, v42, v42 quad_perm:[1,0,3,2] row_mask:0xf bank_mask:0xf
    v_mov_b32 v43, v42
    s_nop 1
    v_permlane16_swap_b32 v42, v43
    v_add_f32 v42, v42, v43
    v_mov_b32 v43, v42
    s_nop 1
    v_permlane32_swap_b32 v42, v43
    v_add_f32 v42, v42, v43
    v_mul_f32 v42, 0x3ae38e39, v42
    v_cvt_pk_bf16_f32 v47, v47, v47
    v_and_b32 v47, 0xffff0000, v47
    v_cvt_pk_bf16_f32 v42, v42, v42
    v_and_b32 v42, 0xffff0000, v42
    v_add_f32 v42, 0x3727c5ac, v42
    v_cvt_pk_bf16_f32 v42, v42, v42
    v_and_b32 v42, 0xffff0000, v42
    v_sqrt_f32 v40, v42
    v_rcp_f32 v41, v40
    v_fma_f32 v43, -v40, v40, v42
    v_mul_f32 v41, 0.5, v41
    v_fmac_f32 v40, v43, v41
    v_cvt_pk_bf16_f32 v40, v40, v40
    v_and_b32 v40, 0xffff0000, v40
    v_rcp_f32 v41, v40
    v_lshlrev_b32 v32, 16, v24
    v_and_b32 v33, 0xffff0000, v24
    v_lshlrev_b32 v34, 16, v25
    v_and_b32 v35, 0xffff0000, v25
    v_lshlrev_b32 v36, 16, v26
    v_and_b32 v37, 0xffff0000, v26
    v_lshlrev_b32 v38, 16, v27
    v_and_b32 v39, 0xffff0000, v27
    v_lshlrev_b32 v44, 16, v28
    v_sub_f32 v32, v32, v47
    v_sub_f32 v33, v33, v47
    v_sub_f32 v34, v34, v47
    v_sub_f32 v35, v35, v47
    v_sub_f32 v36, v36, v47
    v_sub_f32 v37, v37, v47
    v_sub_f32 v38, v38, v47
    v_sub_f32 v39, v39, v47
    v_sub_f32 v44, v44, v47
    v_cvt_pk_bf16_f32 v24, v32, v33
    v_cvt_pk_bf16_f32 v25, v34, v35
    v_cvt_pk_bf16_f32 v26, v36, v37
    v_cvt_pk_bf16_f32 v27, v38, v39
    v_cvt_pk_bf16_f32 v28, v44, v44
    v_lshlrev_b32 v32, 16, v24
    v_and_b32 v33, 0xffff0000, v24
    v_lshlrev_b32 v34, 16, v25
    v_and_b32 v35, 0xffff0000, v25
    v_lshlrev_b32 v36, 16, v26
    v_and_b32 v37, 0xffff0000, v26
    v_lshlrev_b32 v38, 16, v27
    v_and_b32 v39, 0xffff0000, v27
    v_lshlrev_b32 v44, 16, v28
    v_mul_f32 v24, v32, v41
    v_mul_f32 v25, v33, v41
    v_mul_f32 v26, v34, v41
    v_mul_f32 v27, v35, v41
    v_mul_f32 v28, v36, v41
    v_mul_f32 v29, v37, v41
    v_mul_f32 v30, v38, v41
    v_mul_f32 v31, v39, v41
    v_mul_f32 v42, v44, v41
    v_fma_f32 v32, -v24, v40, v32
    v_fma_f32 v33, -v25, v40, v33
    v_fma_f32 v34, -v26, v40, v34
    v_fma_f32 v35, -v27, v40, v35
    v_fma_f32 v36, -v28, v40, v36
    v_fma_f32 v37, -v29, v40, v37
    v_fma_f32 v38, -v30, v40, v38
    v_fma_f32 v39, -v31, v40, v39
    v_fma_f32 v44, -v42, v40, v44
    v_fmac_f32 v24, v32, v41
    v_fmac_f32 v25, v33, v41
    v_fmac_f32 v26, v34, v41
    v_fmac_f32 v27, v35, v41
    v_fmac_f32 v28, v36, v41
    v_fmac_f32 v29, v37, v41
    v_fmac_f32 v30, v38, v41
    v_fmac_f32 v31, v39, v41
    v_fmac_f32 v42, v44, v41
    v_cvt_pk_bf16_f32 v32, v24, v28
    v_cvt_pk_bf16_f32 v33, v25, v29
    v_cvt_pk_bf16_f32 v34, v26, v30
    v_cvt_pk_bf16_f32 v35, v27, v31
    v_cvt_pk_bf16_f32 v36, v42, v42
    ds_write_b128 v1, v[32:35] offset:256
    ds_write_b16 v16, v36 offset:1280
    ds_write_b32 v18, v19 offset:1604
    ds_read_b32 v12, v17 offset:256
    s_waitcnt lgkmcnt(0)
    s_add_u32 s14, s14, 1
    s_cmp_eq_u32 s14, s15
    s_addc_u32 s14, s14, 0
    s_not_b32 s15, s14
    v_mov_b32_dpp v32, v12 row_newbcast:0 row_mask:0xf bank_mask:0xf
    v_perm_b32 v24, v32, v32, v8
    v_perm_b32 v25, v32, v32, v9
    v_perm_b32 v26, v32, v32, v10
    v_perm_b32 v27, v32, v32, v11
    v_mov_b32_dpp v32, v12 row_newbcast:1 row_mask:0xf bank_mask:0xf
    v_perm_b32 v28, v32, v32, v8
    v_perm_b32 v29, v32, v32, v9
    v_perm_b32 v30, v32, v32, v10
    v_perm_b32 v31, v32, v32, v11
    s_waitcnt vmcnt(17)
    v_mfma_f32_16x16x32_bf16 v[16:19], v[24:27], v[48:51], 0
    s_waitcnt vmcnt(16)
    v_mfma_f32_16x16x32_bf16 v[20:23], v[24:27], v[52:55], 0
    v_mov_b32_dpp v32, v12 row_newbcast:2 row_mask:0xf bank_mask:0xf
    v_perm_b32 v24, v32, v32, v8
    v_perm_b32 v25, v32, v32, v9
    v_perm_b32 v26, v32, v32, v10
    v_perm_b32 v27, v32, v32, v11
    s_waitcnt vmcnt(15)
    v_mfma_f32_16x16x32_bf16 v[16:19], v[28:31], v[56:59], v[16:19]
    s_waitcnt vmcnt(14)
    v_mfma_f32_16x16x32_bf16 v[20:23], v[28:31], v[60:63], v[20:23]
    v_mov_b32_dpp v32, v12 row_newbcast:3 row_mask:0xf bank_mask:0xf
    v_perm_b32 v28, v32, v32, v8
    v_perm_b32 v29, v32, v32, v9
    v_perm_b32 v30, v32, v32, v10
    v_perm_b32 v31, v32, v32, v11
    s_waitcnt vmcnt(13)
    v_mfma_f32_16x16x32_bf16 v[16:19], v[24:27], v[64:67], v[16:19]
    s_waitcnt vmcnt(12)
    v_mfma_f32_16x16x32_bf16 v[20:23], v[24:27], v[68:71], v[20:23]
    v_mov_b32_dpp v32, v12 row_newbcast:4 row_mask:0xf bank_mask:0xf
    v_perm_b32 v24, v32, v32, v8
    v_perm_b32 v25, v32, v32, v9
    v_perm_b32 v26, v32, v32, v10
    v_perm_b32 v27, v32, v32, v11
    s_waitcnt vmcnt(11)
    v_mfma_f32_16x16x32_bf16 v[16:19], v[28:31], v[72:75], v[16:19]
    s_waitcnt vmcnt(10)
    v_mfma_f32_16x16x32_bf16 v[20:23], v[28:31], v[76:79], v[20:23]
    v_mov_b32_dpp v32, v12 row_newbcast:5 row_mask:0xf bank_mask:0xf
    v_perm_b32 v28, v32, v32, v8
    v_perm_b32 v29, v32, v32, v9
    v_perm_b32 v30, v32, v32, v10
    v_perm_b32 v31, v32, v32, v11
    s_waitcnt vmcnt(9)
    v_mfma_f32_16x16x32_bf16 v[16:19], v[24:27], v[80:83], v[16:19]
    s_waitcnt vmcnt(8)
    v_mfma_f32_16x16x32_bf16 v[20:23], v[24:27], v[84:87], v[20:23]
    v_mov_b32_dpp v32, v12 row_newbcast:6 row_mask:0xf bank_mask:0xf
    v_perm_b32 v24, v32, v32, v8
    v_perm_b32 v25, v32, v32, v9
    v_perm_b32 v26, v32, v32, v10
    v_perm_b32 v27, v32, v32, v11
    s_waitcnt vmcnt(7)
    v_mfma_f32_16x16x32_bf16 v[16:19], v[28:31], v[88:91], v[16:19]
    s_waitcnt vmcnt(6)
    v_mfma_f32_16x16x32_bf16 v[20:23], v[28:31], v[92:95], v[20:23]
    v_mov_b32_dpp v32, v12 row_newbcast:7 row_mask:0xf bank_mask:0xf
    v_perm_b32 v28, v32, v32, v8
    v_perm_b32 v29, v32, v32, v9
    v_perm_b32 v30, v32, v32, v10
    v_perm_b32 v31, v32, v32, v11
    s_waitcnt vmcnt(5)
    v_mfma_f32_16x16x32_bf16 v[16:19], v[24:27], v[96:99], v[16:19]
    s_waitcnt vmcnt(4)
    v_mfma_f32_16x16x32_bf16 v[20:23], v[24:27], v[100:103], v[20:23]
    v_mov_b32_dpp v32, v12 row_newbcast:8 row_mask:0xf bank_mask:0xf
    v_perm_b32 v24, v32, v32, v8
    v_perm_b32 v25, v32, v32, v9
    v_perm_b32 v26, v32, v32, v10
    v_perm_b32 v27, v32, v32, v11
    s_waitcnt vmcnt(3)
    v_mfma_f32_16x16x32_bf16 v[16:19], v[28:31], v[104:107], v[16:19]
    s_waitcnt vmcnt(2)
    v_mfma_f32_16x16x32_bf16 v[20:23], v[28:31], v[108:111], v[20:23]
    s_waitcnt vmcnt(1)
    v_mfma_f32_16x16x32_bf16 v[16:19], v[24:27], v[112:115], v[16:19]
    s_waitcnt vmcnt(0)
    v_mfma_f32_16x16x32_bf16 v[20:23], v[24:27], v[116:119], v[20:23]
    v_lshlrev_b32 v44, 7, v46
    v_lshl_add_u32 v44, v45, 4, v44
    s_lshl_b32 s73, s64, 15
    s_and_b32 s72, s66, 3
    s_lshl_b32 s72, s72, 10
    s_add_u32 s73, s73, s72
    s_add_u32 s73, s73, 131072
    s_lshl_b32 s72, s67, 12
    s_add_u32 s72, s72, s73
    s_getreg_b32 s79, hwreg(HW_REG_XCC_ID, 0, 3)
    s_xor_b32 s79, s79, s15
    v_permlane32_swap_b32 v16, v18
    v_permlane32_swap_b32 v17, v19
    s_nop 0
    v_add_f32_dpp v16, v18, v16 row_ror:8 row_mask:0xf bank_mask:0xf
    v_add_f32_dpp v17, v19, v17 row_ror:8 row_mask:0xf bank_mask:0xf
    v_mov_b32 v18, s14
    v_mov_b32 v19, s79
    v_permlane32_swap_b32 v20, v22
    v_permlane32_swap_b32 v21, v23
    s_nop 0
    v_add_f32_dpp v20, v22, v20 row_ror:8 row_mask:0xf bank_mask:0xf
    v_add_f32_dpp v21, v23, v21 row_ror:8 row_mask:0xf bank_mask:0xf
    v_mov_b32 v22, s14
    v_mov_b32 v23, s79
    s_mov_b32 exec_lo, 0xff00ff
    s_mov_b32 exec_hi, 0xff00ff
    buffer_store_dwordx4 v[16:19], v44, s[60:63], s72 offen offset:0 sc1
    buffer_store_dwordx4 v[20:23], v44, s[60:63], s72 offen offset:512 sc1
    s_mov_b64 exec, -1
    s_and_b32 s72, s65, 7
    s_lshr_b32 s74, s65, 3
    s_mul_i32 s74, s74, 6
    s_add_u32 s74, s74, s72
    s_cmp_gt_u32 s72, 3
    s_cselect_b32 s75, 2, 1
    s_sub_u32 s74, s74, s75
    s_lshl_b32 s74, s74, 3
    s_add_u32 s78, s74, s64
    s_cmp_eq_u32 s72, 0
    s_cselect_b32 s78, 999, s78
    s_cmp_eq_u32 s72, 3
    s_cselect_b32 s78, 999, s78
    s_sub_u32 s101, s78, 100
    v_lshrrev_b32 v32, 1, v46
    v_and_b32 v33, 1, v46
    v_lshl_add_u32 v32, v33, 1, v32
    v_and_b32 v33, 7, v45
    v_lshl_add_u32 v32, v32, 4, v33
    v_lshlrev_b32 v32, 1, v32
    s_lshr_b32 s72, s101, 1
    s_lshl_b32 s72, s72, 7
    s_and_b32 s74, s101, 1
    s_lshl_b32 s74, s74, 4
    s_add_u32 s72, s72, s74
    v_add_u32 v6, s72, v32
    buffer_load_ushort v2, v6, s[28:31], 0 offen
    s_waitcnt vmcnt(0)
    v_lshrrev_b32 v32, 3, v0
    v_lshlrev_b32 v32, 12, v32
    v_and_b32 v17, 7, v0
    v_lshl_add_u32 v17, v17, 4, v32
    v_lshrrev_b32 v44, 5, v0
    v_lshlrev_b32 v44, 7, v44
    v_and_b32 v32, 7, v0
    v_lshl_add_u32 v44, v32, 4, v44
    v_bfe_u32 v32, v0, 3, 1
    v_lshl_add_u32 v44, v32, 3, v44
    v_bfe_u32 v32, v0, 4, 1
    v_lshl_add_u32 v44, v32, 2, v44
    s_mov_b32 s100, 0x100000
L_qx_2:
    buffer_load_dwordx4 v[48:51], v17, s[60:63], s73 offen offset:0 sc1
    buffer_load_dwordx4 v[52:55], v17, s[60:63], s73 offen offset:128 sc1
    buffer_load_dwordx4 v[56:59], v17, s[60:63], s73 offen offset:256 sc1
    buffer_load_dwordx4 v[60:63], v17, s[60:63], s73 offen offset:384 sc1
    buffer_load_dwordx4 v[64:67], v17, s[60:63], s73 offen offset:512 sc1
    buffer_load_dwordx4 v[68:71], v17, s[60:63], s73 offen offset:640 sc1
    buffer_load_dwordx4 v[72:75], v17, s[60:63], s73 offen offset:768 sc1
    buffer_load_dwordx4 v[76:79], v17, s[60:63], s73 offen offset:896 sc1
    s_waitcnt vmcnt(0)
    v_xor_b32 v50, s14, v50
    v_xor_b32 v51, s79, v51
    v_xor_b32 v54, s14, v54
    v_xor_b32 v55, s79, v55
    v_xor_b32 v58, s14, v58
    v_xor_b32 v59, s79, v59
    v_xor_b32 v62, s14, v62
    v_xor_b32 v63, s79, v63
    v_xor_b32 v66, s14, v66
    v_xor_b32 v67, s79, v67
    v_xor_b32 v70, s14, v70
    v_xor_b32 v71, s79, v71
    v_xor_b32 v74, s14, v74
    v_xor_b32 v75, s79, v75
    v_xor_b32 v78, s14, v78
    v_xor_b32 v79, s79, v79
    v_or_b32 v32, v50, v54
    v_or_b32 v35, v51, v55
    v_or3_b32 v32, v32, v58, v62
    v_or3_b32 v35, v35, v59, v63
    v_or3_b32 v32, v32, v66, v70
    v_or3_b32 v35, v35, v67, v71
    v_or3_b32 v32, v32, v74, v78
    v_or3_b32 v35, v35, v75, v79
    v_and_or_b32 v32, v35, -8, v32
    v_cmp_ne_u32 vcc, 0, v32
    s_nop 0
    s_cbranch_vccz L_qx_2_done
    s_mov_b64 exec, vcc
    s_sub_u32 s100, s100, 1
    s_cmp_lg_u32 s100, 0
    s_cbranch_scc1 L_qx_2
L_qx_2_done:
    s_mov_b64 exec, -1
    v_cmp_ne_u32 vcc, 0, v35
    s_nop 0
    s_cmp_eq_u64 vcc, 0
    s_cselect_b32 s40, 2, 1
    v_permlane32_swap_b32 v48, v64
    v_permlane32_swap_b32 v49, v65
    v_permlane32_swap_b32 v52, v68
    v_permlane32_swap_b32 v53, v69
    v_permlane32_swap_b32 v56, v72
    v_permlane32_swap_b32 v57, v73
    v_permlane32_swap_b32 v60, v76
    v_permlane32_swap_b32 v61, v77
    v_add_f32 v48, v48, v64
    v_add_f32 v49, v49, v65
    v_add_f32 v52, v52, v68
    v_add_f32 v53, v53, v69
    v_add_f32 v56, v56, v72
    v_add_f32 v57, v57, v73
    v_add_f32 v60, v60, v76
    v_add_f32 v61, v61, v77
    v_permlane16_swap_b32 v48, v56
    v_permlane16_swap_b32 v49, v57
    v_permlane16_swap_b32 v52, v60
    v_permlane16_swap_b32 v53, v61
    v_add_f32 v48, v48, v56
    v_add_f32 v49, v49, v57
    v_add_f32 v52, v52, v60
    v_add_f32 v53, v53, v61
    v_add_f32_dpp v48, v48, v48 row_ror:8 row_mask:0xf bank_mask:0x3
    v_add_f32_dpp v49, v49, v49 row_ror:8 row_mask:0xf bank_mask:0x3
    s_nop 0
    v_add_f32_dpp v48, v52, v52 row_ror:8 row_mask:0xf bank_mask:0xc
    v_add_f32_dpp v49, v53, v53 row_ror:8 row_mask:0xf bank_mask:0xc
    v_cvt_pk_bf16_f32 v32, v48, v49
    v_mov_b32 v33, 0
    v_mov_b32 v34, s40
    ds_write_b32 v44, v32 offset:0
    ds_write_b32 v33, v34 offset:1608
    v_lshlrev_b32 v2, 16, v2
    s_mov_b32 s57, s67
    s_and_b32 s72, s65, 7
    s_lshr_b32 s73, s65, 3
    s_cmp_eq_u32 s72, 0
    s_cbranch_scc1 L_a_f1_3
    s_call_b64 s[58:59], L_wo
    s_nop 1
    s_sub_u32 s72, s65, 28
    s_lshl_b32 s72, s72, 3
    s_add_u32 s72, s72, s64
    s_add_u32 s72, s72, 100
    s_cmp_lt_u32 s78, 100
    s_cselect_b32 s56, s78, 999
    s_cmp_eq_u32 s67, 7
    s_cselect_b32 s56, s72, s56
    s_cmp_ge_u32 s56, 132
    s_cbranch_scc1 L_a_done_4
    s_call_b64 s[58:59], L_f2
    s_nop 1
    s_branch L_a_done_4
L_a_f1_3:
    s_mov_b32 s32, s16
    s_mov_b32 s33, s17
    s_mov_b32 s34, 5308416
    s_mov_b32 s35, 0x20000
    s_mov_b32 s36, s18
    s_mov_b32 s37, s19
    s_mov_b32 s38, 5308416
    s_mov_b32 s39, 0x20000
    v_lshrrev_b32 v32, 3, v45
    v_lshl_add_u32 v32, v32, 2, v46
    v_and_b32 v33, 7, v45
    v_lshlrev_b32 v33, 4, v33
    v_mul_u32_u24 v5, 9216, v32
    v_add_u32 v5, v5, v33
    v_lshlrev_b32 v15, 2, v46
    v_lshl_add_u32 v15, v45, 4, v15
    s_lshl_b32 s72, s64, 2
    s_add_u32 s72, s72, s73
    s_and_b32 s56, s72, 7
    s_lshl_b32 s56, s56, 2
    s_lshr_b32 s72, s72, 3
    s_add_u32 s56, s56, s72
    s_add_u32 s56, s56, 256
    s_call_b64 s[58:59], L_f1
    s_nop 1
    s_call_b64 s[58:59], L_wo
    s_nop 1
L_a_done_4:
    s_mov_b32 s76, 0xfff
    v_mov_b32 v12, s14
    v_lshrrev_b32 v13, 12, v12
    v_lshrrev_b32 v14, 24, v12
    v_add3_u32 v13, v13, v12, 21
    v_add3_u32 v14, v14, v12, 42
    v_add_u32 v15, 63, v12
    v_and_b32 v12, s76, v12
    v_and_b32 v13, s76, v13
    v_and_b32 v14, s76, v14
    v_and_b32 v15, s76, v15
    v_lshrrev_b32 v32, 3, v0
    v_lshlrev_b32 v32, 12, v32
    v_and_b32 v17, 7, v0
    v_lshl_add_u32 v17, v17, 4, v32
    v_lshrrev_b32 v32, 3, v0
    v_lshlrev_b32 v32, 8, v32
    v_and_b32 v33, 7, v0
    v_lshl_add_u32 v5, v33, 4, v32
    v_and_b32 v7, 0x3ff, v5
    s_lshr_b32 s72, s101, 1
    s_and_b32 s73, s101, 1
    s_lshl_b32 s73, s73, 7
    s_lshr_b32 s69, s72, 3
    s_lshl_b32 s69, s69, 16
    s_and_b32 s75, s72, 7
    s_lshl_b32 s75, s75, 12
    s_add_u32 s69, s69, s75
    s_add_u32 s69, s69, s73
    s_add_u32 s69, s69, 819200
    s_add_u32 s78, s69, 32768
    s_mul_i32 s72, s72, 9216
    s_add_u32 s72, s72, s73
    s_add_u32 s56, s72, 921600
    s_add_u32 s41, s56, 4096
    s_add_u32 s42, s56, 8192
    s_mov_b32 s73, 40960
    v_lshrrev_b32 v33, 2, v45
    v_lshl_add_u32 v33, v46, 3, v33
    v_and_b32 v34, 3, v45
    v_lshlrev_b32 v34, 3, v34
    v_lshl_add_u32 v33, v33, 7, v34
    v_add_u32 v33, s73, v33
    ds_read_b64_tr_b16 v[104:105], v33 offset:0
    ds_read_b64_tr_b16 v[106:107], v33 offset:512
    ds_read_b64_tr_b16 v[108:109], v33 offset:32
    ds_read_b64_tr_b16 v[110:111], v33 offset:544
    ds_read_b64_tr_b16 v[112:113], v33 offset:64
    ds_read_b64_tr_b16 v[114:115], v33 offset:576
    ds_read_b64_tr_b16 v[116:117], v33 offset:96
    ds_read_b64_tr_b16 v[118:119], v33 offset:608
    s_waitcnt lgkmcnt(0)
    ds_read_b64_tr_b16 v[120:121], v33 offset:4096
    ds_read_b64_tr_b16 v[122:123], v33 offset:4608
    ds_read_b64_tr_b16 v[124:125], v33 offset:4128
    ds_read_b64_tr_b16 v[126:127], v33 offset:4640
    ds_read_b64_tr_b16 v[128:129], v33 offset:4160
    ds_read_b64_tr_b16 v[130:131], v33 offset:4672
    ds_read_b64_tr_b16 v[132:133], v33 offset:4192
    ds_read_b64_tr_b16 v[134:135], v33 offset:4704
    s_waitcnt lgkmcnt(0)
    ds_read_b64_tr_b16 v[136:137], v33 offset:8192
    ds_read_b64_tr_b16 v[138:139], v33 offset:8704
    ds_read_b64_tr_b16 v[140:141], v33 offset:8224
    ds_read_b64_tr_b16 v[142:143], v33 offset:8736
    ds_read_b64_tr_b16 v[144:145], v33 offset:8256
    ds_read_b64_tr_b16 v[146:147], v33 offset:8768
    ds_read_b64_tr_b16 v[148:149], v33 offset:8288
    ds_read_b64_tr_b16 v[150:151], v33 offset:8800
    s_waitcnt lgkmcnt(0)
    ds_read_b64_tr_b16 v[152:153], v33 offset:12288
    ds_read_b64_tr_b16 v[154:155], v33 offset:12800
    ds_read_b64_tr_b16 v[156:157], v33 offset:12320
    ds_read_b64_tr_b16 v[158:159], v33 offset:12832
    ds_read_b64_tr_b16 v[160:161], v33 offset:12352
    ds_read_b64_tr_b16 v[162:163], v33 offset:12864
    ds_read_b64_tr_b16 v[164:165], v33 offset:12384
    ds_read_b64_tr_b16 v[166:167], v33 offset:12896
    s_waitcnt lgkmcnt(0)
    v_lshlrev_b32 v40, 7, v46
    v_lshl_add_u32 v40, v45, 4, v40
    s_lshr_b32 s68, s57, 3
    s_lshl_b32 s68, s68, 16
    s_and_b32 s75, s57, 7
    s_lshl_b32 s75, s75, 12
    s_add_u32 s68, s68, s75
    s_lshr_b32 s73, s66, 4
    s_lshl_b32 s73, s73, 15
    s_and_b32 s72, s66, 15
    s_lshl_b32 s72, s72, 8
    s_add_u32 s73, s73, s72
    s_add_u32 s68, s68, s73
    s_add_u32 s68, s68, 819200
    s_lshr_b32 s71, s66, 3
    s_lshl_b32 s71, s71, 15
    s_and_b32 s72, s66, 7
    s_lshl_b32 s72, s72, 9
    s_add_u32 s71, s71, s72
    s_add_u32 s71, s71, 393216
    s_lshl_b32 s72, s67, 12
    s_add_u32 s70, s71, s72
    v_lshlrev_b32 v43, 3, v0
    s_branch L_tail
L_auxb:
    s_and_b32 s72, s65, 7
    s_lshr_b32 s74, s65, 3
    s_mul_i32 s74, s74, 6
    s_add_u32 s74, s74, s72
    s_cmp_gt_u32 s72, 3
    s_cselect_b32 s75, 2, 1
    s_sub_u32 s74, s74, s75
    s_lshl_b32 s74, s74, 3
    s_add_u32 s78, s74, s64
    s_cmp_eq_u32 s72, 0
    s_cselect_b32 s78, 999, s78
    s_cmp_eq_u32 s72, 3
    s_cselect_b32 s78, 999, s78
    s_lshr_b32 s72, s64, 2
    s_lshl_b32 s72, s72, 5
    s_add_u32 s72, s72, s65
    s_lshl_b32 s72, s72, 2
    s_and_b32 s56, s64, 3
    s_add_u32 s56, s56, s72
    s_waitcnt lgkmcnt(0)
    s_mov_b32 s32, s16
    s_mov_b32 s33, s17
    s_mov_b32 s34, 5308416
    s_mov_b32 s35, 0x20000
    s_mov_b32 s36, s18
    s_mov_b32 s37, s19
    s_mov_b32 s38, 5308416
    s_mov_b32 s39, 0x20000
    v_lshrrev_b32 v32, 3, v45
    v_lshl_add_u32 v32, v32, 2, v46
    v_and_b32 v33, 7, v45
    v_lshlrev_b32 v33, 4, v33
    v_mul_u32_u24 v5, 9216, v32
    v_add_u32 v5, v5, v33
    v_lshlrev_b32 v15, 2, v46
    v_lshl_add_u32 v15, v45, 4, v15
    v_mul_u32_u24 v3, 1152, v32
    v_add_u32 v3, v3, v33
    s_mov_b32 s60, s26
    s_mov_b32 s61, s27
    s_mov_b32 s62, 268435456
    s_mov_b32 s63, 0x20000
    s_mov_b32 s44, s12
    s_mov_b32 s45, s13
    s_mov_b32 s46, 4718592
    s_mov_b32 s47, 0x20000
    s_mov_b32 s48, s20
    s_mov_b32 s49, s21
    s_mov_b32 s50, 5308416
    s_mov_b32 s51, 0x20000
    s_mov_b32 s52, s22
    s_mov_b32 s53, s23
    s_mov_b32 s54, 1152
    s_mov_b32 s55, 0x20000
    v_mov_b32 v6, 0
    v_mov_b32 v7, 0
    s_load_dword s14, s[26:27], 0
    s_load_dword s15, s[26:27], 1040384
    v_lshrrev_b32 v32, 3, v45
    v_mul_u32_u24 v32, 0x202, v32
    v_add_u32 v32, 0x100, v32
    v_lshlrev_b32 v33, 16, v32
    v_or_b32 v33, 0xc0c, v33
    v_or_b32 v32, 0xc0c0000, v32
    v_and_b32 v34, 1, v45
    v_cmp_eq_u32 vcc, 1, v34
    s_nop 1
    v_cndmask_b32 v32, v32, v33, vcc
    v_bfe_u32 v34, v45, 1, 2
    v_mov_b32 v33, 0xc0c0c0c
    v_cmp_eq_u32 vcc, 0, v34
    s_nop 1
    v_cndmask_b32 v8, v33, v32, vcc
    v_cmp_eq_u32 vcc, 1, v34
    s_nop 1
    v_cndmask_b32 v9, v33, v32, vcc
    v_cmp_eq_u32 vcc, 2, v34
    s_nop 1
    v_cndmask_b32 v10, v33, v32, vcc
    v_cmp_eq_u32 vcc, 3, v34
    s_nop 1
    v_cndmask_b32 v11, v33, v32, vcc
    s_waitcnt lgkmcnt(0)
    s_add_u32 s14, s14, 1
    s_cmp_eq_u32 s14, s15
    s_addc_u32 s14, s14, 0
    s_not_b32 s15, s14
    s_barrier
    s_call_b64 s[58:59], L_f1
    s_nop 1
    v_mov_b32 v47, 0
    s_mov_b32 s100, 0x800000
L_ml_5:
    ds_read_b32 v32, v47 offset:1600
    s_waitcnt lgkmcnt(0)
    v_cmp_gt_u32 vcc, 8, v32
    s_nop 1
    s_cbranch_vccz L_ml_5_done
    s_sleep 2
    s_sub_u32 s100, s100, 1
    s_cmp_lg_u32 s100, 0
    s_cbranch_scc1 L_ml_5
L_ml_5_done:
    v_and_b32 v44, 7, v0
    v_lshlrev_b32 v44, 3, v44
    ds_read_b64 v[20:21], v44 offset:1536
    ds_read_b32 v22, v47 offset:1608
    s_lshl_b32 s72, s66, 4
    s_add_u32 s72, s72, s67
    s_lshl_b32 s72, s72, 4
    s_add_u32 s72, s72, 1028096
    v_mov_b32 v38, s14
    v_mov_b32 v39, s15
    s_waitcnt lgkmcnt(0)
    v_mov_b32 v36, v20
    s_nop 1
    v_max_f32_dpp v36, v36, v36 row_half_mirror row_mask:0xf bank_mask:0xf
    s_nop 1
    v_max_f32_dpp v36, v36, v36 quad_perm:[2,3,0,1] row_mask:0xf bank_mask:0xf
    s_nop 1
    v_max_f32_dpp v36, v36, v36 quad_perm:[1,0,3,2] row_mask:0xf bank_mask:0xf
    v_sub_f32 v37, v20, v36
    v_mul_f32 v37, 0x3fb8aa3b, v37
    v_exp_f32 v37, v37
    s_nop 0
    v_mul_f32 v37, v37, v21
    s_nop 1
    v_add_f32_dpp v37, v37, v37 row_half_mirror row_mask:0xf bank_mask:0xf
    s_nop 1
    v_add_f32_dpp v37, v37, v37 quad_perm:[2,3,0,1] row_mask:0xf bank_mask:0xf
    s_nop 1
    v_add_f32_dpp v37, v37, v37 quad_perm:[1,0,3,2] row_mask:0xf bank_mask:0xf
    v_readfirstlane_b32 s40, v22
    s_mov_b32 exec_lo, 0x1
    s_mov_b32 exec_hi, 0x0
    s_cmp_eq_u32 s40, 2
    s_cbranch_scc0 L_far_6
    buffer_store_dwordx4 v[36:39], v47, s[60:63], s72 offen
    s_branch L_far_6_done
L_far_6:
    buffer_store_dwordx4 v[36:39], v47, s[60:63], s72 offen sc1
L_far_6_done:
    s_mov_b64 exec, -1
    s_cmp_eq_u32 s67, 7
    s_cbranch_scc1 L_b_late_7
    s_and_b32 s72, s65, 7
    s_cmp_eq_u32 s72, 0
    s_cbranch_scc1 L_b_late_7
    s_lshr_b32 s73, s65, 3
    s_sub_u32 s56, s65, s73
    s_sub_u32 s56, s56, 1
    s_lshl_b32 s56, s56, 3
    s_add_u32 s56, s56, s64
    s_add_u32 s56, s56, 132
    s_call_b64 s[58:59], L_f2
    s_nop 1
    s_sub_u32 s101, s78, 100
    s_cmp_ge_u32 s101, 18
    s_cbranch_scc1 L_fin
    v_lshrrev_b32 v32, 3, v0
    v_lshlrev_b32 v32, 8, v32
    v_and_b32 v33, 7, v0
    v_lshl_add_u32 v5, v33, 4, v32
    v_and_b32 v7, 0x3ff, v5
    s_lshr_b32 s72, s101, 1
    s_and_b32 s73, s101, 1
    s_lshl_b32 s73, s73, 7
    s_lshr_b32 s69, s72, 3
    s_lshl_b32 s69, s69, 16
    s_and_b32 s75, s72, 7
    s_lshl_b32 s75, s75, 12
    s_add_u32 s69, s69, s75
    s_add_u32 s69, s69, s73
    s_add_u32 s69, s69, 819200
    s_add_u32 s78, s69, 32768
    s_mul_i32 s72, s72, 9216
    s_add_u32 s72, s72, s73
    s_add_u32 s56, s72, 921600
    s_add_u32 s41, s56, 4096
    s_add_u32 s42, s56, 8192
    s_branch L_fyb
L_b_late_7:
    s_cmp_lg_u32 s67, 7
    s_cbranch_scc1 L_fin
    s_mov_b32 s57, 8
    s_mul_i32 s71, s66, 147456
    s_lshl_b32 s73, s57, 7
    s_add_u32 s71, s71, s73
    buffer_load_dwordx4 v[104:107], v3, s[44:47], s71 offen nt
    s_add_u32 s71, s71, 9216
    buffer_load_dwordx4 v[108:111], v3, s[44:47], s71 offen nt
    s_add_u32 s71, s71, 9216
    buffer_load_dwordx4 v[112:115], v3, s[44:47], s71 offen nt
    s_add_u32 s71, s71, 9216
    buffer_load_dwordx4 v[116:119], v3, s[44:47], s71 offen nt
    s_add_u32 s71, s71, 9216
    buffer_load_dwordx4 v[120:123], v3, s[44:47], s71 offen nt
    s_add_u32 s71, s71, 9216
    buffer_load_dwordx4 v[124:127], v3, s[44:47], s71 offen nt
    s_add_u32 s71, s71, 9216
    buffer_load_dwordx4 v[128:131], v3, s[44:47], s71 offen nt
    s_add_u32 s71, s71, 9216
    buffer_load_dwordx4 v[132:135], v3, s[44:47], s71 offen nt
    s_add_u32 s71, s71, 9216
    s_waitcnt vmcnt(7)
    buffer_load_dwordx4 v[136:139], v3, s[44:47], s71 offen nt
    s_add_u32 s71, s71, 9216
    s_waitcnt vmcnt(7)
    buffer_load_dwordx4 v[140:143], v3, s[44:47], s71 offen nt
    s_add_u32 s71, s71, 9216
    s_waitcnt vmcnt(7)
    buffer_load_dwordx4 v[144:147], v3, s[44:47], s71 offen nt
    s_add_u32 s71, s71, 9216
    s_waitcnt vmcnt(7)
    buffer_load_dwordx4 v[148:151], v3, s[44:47], s71 offen nt
    s_add_u32 s71, s71, 9216
    s_waitcnt vmcnt(7)
    buffer_load_dwordx4 v[152:155], v3, s[44:47], s71 offen nt
    s_add_u32 s71, s71, 9216
    s_waitcnt vmcnt(7)
    buffer_load_dwordx4 v[156:159], v3, s[44:47], s71 offen nt
    s_add_u32 s71, s71, 9216
    s_waitcnt vmcnt(7)
    buffer_load_dwordx4 v[160:163], v3, s[44:47], s71 offen nt
    s_add_u32 s71, s71, 9216
    s_waitcnt vmcnt(7)
    buffer_load_dwordx4 v[164:167], v3, s[44:47], s71 offen nt
    s_mov_b32 s76, 0xfff
    v_mov_b32 v12, s14
    v_lshrrev_b32 v13, 12, v12
    v_lshrrev_b32 v14, 24, v12
    v_add3_u32 v13, v13, v12, 21
    v_add3_u32 v14, v14, v12, 42
    v_add_u32 v15, 63, v12
    v_and_b32 v12, s76, v12
    v_and_b32 v13, s76, v13
    v_and_b32 v14, s76, v14
    v_and_b32 v15, s76, v15
    v_lshrrev_b32 v32, 3, v0
    v_lshlrev_b32 v32, 12, v32
    v_and_b32 v17, 7, v0
    v_lshl_add_u32 v17, v17, 4, v32
    s_waitcnt vmcnt(0)
    s_sub_u32 s73, s3, 8
    s_lshl_b32 s73, s73, 14
    s_add_u32 s73, s73, 8192
    v_lshrrev_b32 v32, 3, v45
    v_lshl_add_u32 v32, v32, 2, v46
    v_and_b32 v33, 7, v45
    v_lshlrev_b32 v33, 4, v33
    v_lshl_add_u32 v32, v32, 7, v33
    v_add_u32 v32, s73, v32
    ds_write_b128 v32, v[104:107] offset:0
    ds_write_b128 v32, v[108:111] offset:1024
    ds_write_b128 v32, v[112:115] offset:2048
    ds_write_b128 v32, v[116:119] offset:3072
    ds_write_b128 v32, v[120:123] offset:4096
    ds_write_b128 v32, v[124:127] offset:5120
    ds_write_b128 v32, v[128:131] offset:6144
    ds_write_b128 v32, v[132:135] offset:7168
    ds_write_b128 v32, v[136:139] offset:8192
    ds_write_b128 v32, v[140:143] offset:9216
    ds_write_b128 v32, v[144:147] offset:10240
    ds_write_b128 v32, v[148:151] offset:11264
    ds_write_b128 v32, v[152:155] offset:12288
    ds_write_b128 v32, v[156:159] offset:13312
    ds_write_b128 v32, v[160:163] offset:14336
    ds_write_b128 v32, v[164:167] offset:15360
    v_lshrrev_b32 v33, 2, v45
    v_lshl_add_u32 v33, v46, 3, v33
    v_and_b32 v34, 3, v45
    v_lshlrev_b32 v34, 3, v34
    v_lshl_add_u32 v33, v33, 7, v34
    v_add_u32 v33, s73, v33
    ds_read_b64_tr_b16 v[104:105], v33 offset:0
    ds_read_b64_tr_b16 v[106:107], v33 offset:512
    ds_read_b64_tr_b16 v[108:109], v33 offset:32
    ds_read_b64_tr_b16 v[110:111], v33 offset:544
    ds_read_b64_tr_b16 v[112:113], v33 offset:64
    ds_read_b64_tr_b16 v[114:115], v33 offset:576
    ds_read_b64_tr_b16 v[116:117], v33 offset:96
    ds_read_b64_tr_b16 v[118:119], v33 offset:608
    s_waitcnt lgkmcnt(0)
    ds_read_b64_tr_b16 v[120:121], v33 offset:4096
    ds_read_b64_tr_b16 v[122:123], v33 offset:4608
    ds_read_b64_tr_b16 v[124:125], v33 offset:4128
    ds_read_b64_tr_b16 v[126:127], v33 offset:4640
    ds_read_b64_tr_b16 v[128:129], v33 offset:4160
    ds_read_b64_tr_b16 v[130:131], v33 offset:4672
    ds_read_b64_tr_b16 v[132:133], v33 offset:4192
    ds_read_b64_tr_b16 v[134:135], v33 offset:4704
    s_waitcnt lgkmcnt(0)
    ds_read_b64_tr_b16 v[136:137], v33 offset:8192
    ds_read_b64_tr_b16 v[138:139], v33 offset:8704
    ds_read_b64_tr_b16 v[140:141], v33 offset:8224
    ds_read_b64_tr_b16 v[142:143], v33 offset:8736
    ds_read_b64_tr_b16 v[144:145], v33 offset:8256
    ds_read_b64_tr_b16 v[146:147], v33 offset:8768
    ds_read_b64_tr_b16 v[148:149], v33 offset:8288
    ds_read_b64_tr_b16 v[150:151], v33 offset:8800
    s_waitcnt lgkmcnt(0)
    ds_read_b64_tr_b16 v[152:153], v33 offset:12288
    ds_read_b64_tr_b16 v[154:155], v33 offset:12800
    ds_read_b64_tr_b16 v[156:157], v33 offset:12320
    ds_read_b64_tr_b16 v[158:159], v33 offset:12832
    ds_read_b64_tr_b16 v[160:161], v33 offset:12352
    ds_read_b64_tr_b16 v[162:163], v33 offset:12864
    ds_read_b64_tr_b16 v[164:165], v33 offset:12384
    ds_read_b64_tr_b16 v[166:167], v33 offset:12896
    s_waitcnt lgkmcnt(0)
    v_lshlrev_b32 v40, 7, v46
    v_lshl_add_u32 v40, v45, 4, v40
    s_lshr_b32 s68, s57, 3
    s_lshl_b32 s68, s68, 16
    s_and_b32 s75, s57, 7
    s_lshl_b32 s75, s75, 12
    s_add_u32 s68, s68, s75
    s_lshr_b32 s73, s66, 4
    s_lshl_b32 s73, s73, 15
    s_and_b32 s72, s66, 15
    s_lshl_b32 s72, s72, 8
    s_add_u32 s73, s73, s72
    s_add_u32 s68, s68, s73
    s_add_u32 s68, s68, 819200
    s_lshr_b32 s71, s66, 3
    s_lshl_b32 s71, s71, 15
    s_and_b32 s72, s66, 7
    s_lshl_b32 s72, s72, 9
    s_add_u32 s71, s71, s72
    s_add_u32 s71, s71, 393216
    s_lshl_b32 s72, s67, 12
    s_add_u32 s70, s71, s72
    v_lshlrev_b32 v43, 3, v0
L_tail:
    s_waitcnt lgkmcnt(0)
    s_barrier
    s_cmp_lg_u32 s3, 8
    s_cbranch_scc1 L_wait_o_8
    ds_read_b64 v[24:25], v43 offset:4096
    ds_read_b64 v[26:27], v43 offset:4608
    ds_read_b64 v[28:29], v43 offset:5120
    ds_read_b64 v[30:31], v43 offset:5632
    ds_read_b64 v[32:33], v43 offset:6144
    ds_read_b64 v[34:35], v43 offset:6656
    ds_read_b64 v[36:37], v43 offset:7168
    ds_read_b64 v[38:39], v43 offset:7680
    s_waitcnt lgkmcnt(0)
    v_add_f32 v24, v24, v32
    v_add_f32 v26, v26, v34
    v_add_f32 v28, v28, v36
    v_add_f32 v30, v30, v38
    v_add_f32 v25, v25, v33
    v_add_f32 v27, v27, v35
    v_add_f32 v29, v29, v37
    v_add_f32 v31, v31, v39
    v_add_f32 v24, v24, v26
    v_add_f32 v28, v28, v30
    v_add_f32 v25, v25, v27
    v_add_f32 v29, v29, v31
    v_add_f32 v24, v24, v28
    v_add_f32 v25, v25, v29
    s_nop 0
    v_mov_b32_dpp v26, v24 row_ror:8 row_mask:0xf bank_mask:0xf
    v_mov_b32_dpp v27, v25 row_ror:8 row_mask:0xf bank_mask:0xf
    v_add_u32 v24, 0x800, v24
    v_add_u32 v25, 0x800, v25
    v_add_u32 v26, 0x800, v26
    v_add_u32 v27, 0x800, v27
    v_bfi_b32 v24, s76, v12, v24
    v_bfi_b32 v25, s76, v13, v25
    v_bfi_b32 v26, s76, v14, v26
    v_bfi_b32 v27, s76, v15, v27
    s_mov_b32 exec_lo, 0xff00ff
    s_mov_b32 exec_hi, 0xff00ff
    s_cmp_eq_u32 s40, 2
    s_cbranch_scc0 L_far_9
    buffer_store_dwordx4 v[24:27], v40, s[60:63], s70 offen
    s_branch L_far_9_done
L_far_9:
    buffer_store_dwordx4 v[24:27], v40, s[60:63], s70 offen sc1
L_far_9_done:
    s_mov_b64 exec, -1
L_wait_o_8:
    buffer_load_dwordx4 v[64:67], v17, s[60:63], s71 offen offset:0 sc1
    buffer_load_dwordx4 v[68:71], v17, s[60:63], s71 offen offset:128 sc1
    buffer_load_dwordx4 v[72:75], v17, s[60:63], s71 offen offset:256 sc1
    buffer_load_dwordx4 v[76:79], v17, s[60:63], s71 offen offset:384 sc1
    s_sleep 6
    buffer_load_dwordx4 v[80:83], v17, s[60:63], s71 offen offset:0 sc1
    buffer_load_dwordx4 v[84:87], v17, s[60:63], s71 offen offset:128 sc1
    buffer_load_dwordx4 v[88:91], v17, s[60:63], s71 offen offset:256 sc1
    buffer_load_dwordx4 v[92:95], v17, s[60:63], s71 offen offset:384 sc1
    s_mov_b32 s100, 1048576
L_o_10:
    s_waitcnt vmcnt(4)
    v_xor_b32 v48, v64, v12
    v_xor_b32 v49, v65, v13
    v_xor_b32 v50, v66, v14
    v_xor_b32 v51, v67, v15
    v_xor_b32 v52, v68, v12
    v_xor_b32 v53, v69, v13
    v_xor_b32 v54, v70, v14
    v_xor_b32 v55, v71, v15
    v_xor_b32 v56, v72, v12
    v_xor_b32 v57, v73, v13
    v_xor_b32 v58, v74, v14
    v_xor_b32 v59, v75, v15
    v_xor_b32 v60, v76, v12
    v_xor_b32 v61, v77, v13
    v_xor_b32 v62, v78, v14
    v_xor_b32 v63, v79, v15
    v_or3_b32 v32, v48, v49, v50
    v_or3_b32 v33, v51, v52, v53
    v_or3_b32 v33, v33, v54, v55
    v_or3_b32 v32, v32, v56, v57
    v_or3_b32 v33, v33, v58, v59
    v_or3_b32 v32, v32, v60, v61
    v_or3_b32 v33, v33, v62, v63
    v_or_b32 v32, v32, v33
    v_and_b32 v32, s76, v32
    v_cmp_ne_u32 vcc, 0, v32
    s_nop 0
    s_cbranch_vccz L_o_10_done
    s_mov_b64 exec, vcc
    buffer_load_dwordx4 v[64:67], v17, s[60:63], s71 offen offset:0 sc1
    buffer_load_dwordx4 v[68:71], v17, s[60:63], s71 offen offset:128 sc1
    buffer_load_dwordx4 v[72:75], v17, s[60:63], s71 offen offset:256 sc1
    buffer_load_dwordx4 v[76:79], v17, s[60:63], s71 offen offset:384 sc1
    s_waitcnt vmcnt(4)
    v_xor_b32 v48, v80, v12
    v_xor_b32 v49, v81, v13
    v_xor_b32 v50, v82, v14
    v_xor_b32 v51, v83, v15
    v_xor_b32 v52, v84, v12
    v_xor_b32 v53, v85, v13
    v_xor_b32 v54, v86, v14
    v_xor_b32 v55, v87, v15
    v_xor_b32 v56, v88, v12
    v_xor_b32 v57, v89, v13
    v_xor_b32 v58, v90, v14
    v_xor_b32 v59, v91, v15
    v_xor_b32 v60, v92, v12
    v_xor_b32 v61, v93, v13
    v_xor_b32 v62, v94, v14
    v_xor_b32 v63, v95, v15
    v_or3_b32 v32, v48, v49, v50
    v_or3_b32 v33, v51, v52, v53
    v_or3_b32 v33, v33, v54, v55
    v_or3_b32 v32, v32, v56, v57
    v_or3_b32 v33, v33, v58, v59
    v_or3_b32 v32, v32, v60, v61
    v_or3_b32 v33, v33, v62, v63
    v_or_b32 v32, v32, v33
    v_and_b32 v32, s76, v32
    v_cmp_ne_u32 vcc, 0, v32
    s_nop 0
    s_cbranch_vccz L_o_10_done
    s_mov_b64 exec, vcc
    buffer_load_dwordx4 v[80:83], v17, s[60:63], s71 offen offset:0 sc1
    buffer_load_dwordx4 v[84:87], v17, s[60:63], s71 offen offset:128 sc1
    buffer_load_dwordx4 v[88:91], v17, s[60:63], s71 offen offset:256 sc1
    buffer_load_dwordx4 v[92:95], v17, s[60:63], s71 offen offset:384 sc1
    s_sub_u32 s100, s100, 1
    s_cmp_lg_u32 s100, 0
    s_cbranch_scc1 L_o_10
L_o_10_done:
    s_mov_b64 exec, -1
    v_permlane32_swap_b32 v48, v56
    v_permlane32_swap_b32 v49, v57
    v_permlane32_swap_b32 v50, v58
    v_permlane32_swap_b32 v51, v59
    v_permlane32_swap_b32 v52, v60
    v_permlane32_swap_b32 v53, v61
    v_permlane32_swap_b32 v54, v62
    v_permlane32_swap_b32 v55, v63
    v_add_f32 v48, v48, v56
    v_add_f32 v49, v49, v57
    v_add_f32 v50, v50, v58
    v_add_f32 v51, v51, v59
    v_add_f32 v52, v52, v60
    v_add_f32 v53, v53, v61
    v_add_f32 v54, v54, v62
    v_add_f32 v55, v55, v63
    v_permlane16_swap_b32 v48, v52
    v_permlane16_swap_b32 v49, v53
    v_permlane16_swap_b32 v50, v54
    v_permlane16_swap_b32 v51, v55
    v_add_f32 v48, v48, v52
    v_add_f32 v49, v49, v53
    v_add_f32 v50, v50, v54
    v_add_f32 v51, v51, v55
    v_add_f32_dpp v48, v48, v48 row_ror:8 row_mask:0xf bank_mask:0x3
    v_add_f32_dpp v49, v49, v49 row_ror:8 row_mask:0xf bank_mask:0x3
    s_nop 0
    v_add_f32_dpp v48, v50, v50 row_ror:8 row_mask:0xf bank_mask:0xc
    v_add_f32_dpp v49, v51, v51 row_ror:8 row_mask:0xf bank_mask:0xc
    v_cvt_pk_bf16_f32 v42, v48, v49
    s_nop 1
    v_mov_b32_dpp v96, v42 row_newbcast:0 row_mask:0xf bank_mask:0xf
    v_mov_b32_dpp v97, v42 row_newbcast:1 row_mask:0xf bank_mask:0xf
    v_mov_b32_dpp v98, v42 row_newbcast:2 row_mask:0xf bank_mask:0xf
    v_mov_b32_dpp v99, v42 row_newbcast:3 row_mask:0xf bank_mask:0xf
    v_mov_b32_dpp v100, v42 row_newbcast:4 row_mask:0xf bank_mask:0xf
    v_mov_b32_dpp v101, v42 row_newbcast:5 row_mask:0xf bank_mask:0xf
    v_mov_b32_dpp v102, v42 row_newbcast:6 row_mask:0xf bank_mask:0xf
    v_mov_b32_dpp v103, v42 row_newbcast:7 row_mask:0xf bank_mask:0xf
    v_mfma_f32_16x16x32_bf16 v[24:27], v[96:99], v[104:107], 0
    v_mfma_f32_16x16x32_bf16 v[28:31], v[96:99], v[108:111], 0
    v_mfma_f32_16x16x32_bf16 v[32:35], v[96:99], v[112:115], 0
    v_mfma_f32_16x16x32_bf16 v[36:39], v[96:99], v[116:119], 0
    v_mov_b32_dpp v96, v42 row_newbcast:8 row_mask:0xf bank_mask:0xf
    v_mov_b32_dpp v97, v42 row_newbcast:9 row_mask:0xf bank_mask:0xf
    v_mov_b32_dpp v98, v42 row_newbcast:10 row_mask:0xf bank_mask:0xf
    v_mov_b32_dpp v99, v42 row_newbcast:11 row_mask:0xf bank_mask:0xf
    v_mfma_f32_16x16x32_bf16 v[24:27], v[100:103], v[120:123], v[24:27]
    v_mfma_f32_16x16x32_bf16 v[28:31], v[100:103], v[124:127], v[28:31]
    v_mfma_f32_16x16x32_bf16 v[32:35], v[100:103], v[128:131], v[32:35]
    v_mfma_f32_16x16x32_bf16 v[36:39], v[100:103], v[132:135], v[36:39]
    v_mov_b32_dpp v100, v42 row_newbcast:12 row_mask:0xf bank_mask:0xf
    v_mov_b32_dpp v101, v42 row_newbcast:13 row_mask:0xf bank_mask:0xf
    v_mov_b32_dpp v102, v42 row_newbcast:14 row_mask:0xf bank_mask:0xf
    v_mov_b32_dpp v103, v42 row_newbcast:15 row_mask:0xf bank_mask:0xf
    v_mfma_f32_16x16x32_bf16 v[24:27], v[96:99], v[136:139], v[24:27]
    v_mfma_f32_16x16x32_bf16 v[28:31], v[96:99], v[140:143], v[28:31]
    v_mfma_f32_16x16x32_bf16 v[32:35], v[96:99], v[144:147], v[32:35]
    v_mfma_f32_16x16x32_bf16 v[36:39], v[96:99], v[148:151], v[36:39]
    v_mfma_f32_16x16x32_bf16 v[24:27], v[100:103], v[152:155], v[24:27]
    v_mfma_f32_16x16x32_bf16 v[28:31], v[100:103], v[156:159], v[28:31]
    v_mfma_f32_16x16x32_bf16 v[32:35], v[100:103], v[160:163], v[32:35]
    v_mfma_f32_16x16x32_bf16 v[36:39], v[100:103], v[164:167], v[36:39]
    s_nop 4
    v_add_u32 v20, 0x800, v24
    v_add_u32 v21, 0x800, v28
    v_add_u32 v22, 0x800, v32
    v_add_u32 v23, 0x800, v36
    v_bfi_b32 v20, s76, v12, v20
    v_bfi_b32 v21, s76, v13, v21
    v_bfi_b32 v22, s76, v14, v22
    v_bfi_b32 v23, s76, v15, v23
    s_mov_b32 exec_lo, 0xffff
    s_mov_b32 exec_hi, 0x0
    buffer_store_dwordx4 v[20:23], v1, s[60:63], s68 offen sc1
    s_mov_b64 exec, -1
    s_cmp_lg_u32 s3, 8
    s_cbranch_scc1 L_fin
    s_cmp_ge_u32 s101, 18
    s_cbranch_scc1 L_fin
    buffer_load_dwordx4 v[104:107], v5, s[60:63], s69 offen offset:0 sc1
    buffer_load_dwordx4 v[108:111], v5, s[60:63], s69 offen offset:2048 sc1
    buffer_load_dwordx4 v[112:115], v5, s[60:63], s78 offen offset:0 sc1
    buffer_load_dwordx4 v[116:119], v5, s[60:63], s78 offen offset:2048 sc1
    s_sleep 4
    buffer_load_dwordx4 v[120:123], v5, s[60:63], s69 offen offset:0 sc1
    buffer_load_dwordx4 v[124:127], v5, s[60:63], s69 offen offset:2048 sc1
    buffer_load_dwordx4 v[128:131], v5, s[60:63], s78 offen offset:0 sc1
    buffer_load_dwordx4 v[132:135], v5, s[60:63], s78 offen offset:2048 sc1
    s_sleep 4
    buffer_load_dwordx4 v[136:139], v5, s[60:63], s69 offen offset:0 sc1
    buffer_load_dwordx4 v[140:143], v5, s[60:63], s69 offen offset:2048 sc1
    buffer_load_dwordx4 v[144:147], v5, s[60:63], s78 offen offset:0 sc1
    buffer_load_dwordx4 v[148:151], v5, s[60:63], s78 offen offset:2048 sc1
    s_sleep 4
    buffer_load_dwordx4 v[152:155], v5, s[60:63], s69 offen offset:0 sc1
    buffer_load_dwordx4 v[156:159], v5, s[60:63], s69 offen offset:2048 sc1
    buffer_load_dwordx4 v[160:163], v5, s[60:63], s78 offen offset:0 sc1
    buffer_load_dwordx4 v[164:167], v5, s[60:63], s78 offen offset:2048 sc1
    s_mov_b32 s100, 1048576
L_y_11:
    s_waitcnt vmcnt(12)
    v_xor_b32 v48, v104, v12
    v_xor_b32 v49, v105, v13
    v_xor_b32 v50, v106, v14
    v_xor_b32 v51, v107, v15
    v_xor_b32 v52, v108, v12
    v_xor_b32 v53, v109, v13
    v_xor_b32 v54, v110, v14
    v_xor_b32 v55, v111, v15
    v_xor_b32 v56, v112, v12
    v_xor_b32 v57, v113, v13
    v_xor_b32 v58, v114, v14
    v_xor_b32 v59, v115, v15
    v_xor_b32 v60, v116, v12
    v_xor_b32 v61, v117, v13
    v_xor_b32 v62, v118, v14
    v_xor_b32 v63, v119, v15
    v_or3_b32 v32, v48, v49, v50
    v_or3_b32 v33, v51, v52, v53
    v_or3_b32 v33, v33, v54, v55
    v_or3_b32 v32, v32, v56, v57
    v_or3_b32 v33, v33, v58, v59
    v_or3_b32 v32, v32, v60, v61
    v_or3_b32 v33, v33, v62, v63
    v_or_b32 v32, v32, v33
    v_and_b32 v32, s76, v32
    v_cmp_ne_u32 vcc, 0, v32
    s_nop 0
    s_cbranch_vccz L_y_11_done
    s_mov_b64 exec, vcc
    buffer_load_dwordx4 v[104:107], v5, s[60:63], s69 offen offset:0 sc1
    buffer_load_dwordx4 v[108:111], v5, s[60:63], s69 offen offset:2048 sc1
    buffer_load_dwordx4 v[112:115], v5, s[60:63], s78 offen offset:0 sc1
    buffer_load_dwordx4 v[116:119], v5, s[60:63], s78 offen offset:2048 sc1
    s_waitcnt vmcnt(12)
    v_xor_b32 v48, v120, v12
    v_xor_b32 v49, v121, v13
    v_xor_b32 v50, v122, v14
    v_xor_b32 v51, v123, v15
    v_xor_b32 v52, v124, v12
    v_xor_b32 v53, v125, v13
    v_xor_b32 v54, v126, v14
    v_xor_b32 v55, v127, v15
    v_xor_b32 v56, v128, v12
    v_xor_b32 v57, v129, v13
    v_xor_b32 v58, v130, v14
    v_xor_b32 v59, v131, v15
    v_xor_b32 v60, v132, v12
    v_xor_b32 v61, v133, v13
    v_xor_b32 v62, v134, v14
    v_xor_b32 v63, v135, v15
    v_or3_b32 v32, v48, v49, v50
    v_or3_b32 v33, v51, v52, v53
    v_or3_b32 v33, v33, v54, v55
    v_or3_b32 v32, v32, v56, v57
    v_or3_b32 v33, v33, v58, v59
    v_or3_b32 v32, v32, v60, v61
    v_or3_b32 v33, v33, v62, v63
    v_or_b32 v32, v32, v33
    v_and_b32 v32, s76, v32
    v_cmp_ne_u32 vcc, 0, v32
    s_nop 0
    s_cbranch_vccz L_y_11_done
    s_mov_b64 exec, vcc
    buffer_load_dwordx4 v[120:123], v5, s[60:63], s69 offen offset:0 sc1
    buffer_load_dwordx4 v[124:127], v5, s[60:63], s69 offen offset:2048 sc1
    buffer_load_dwordx4 v[128:131], v5, s[60:63], s78 offen offset:0 sc1
    buffer_load_dwordx4 v[132:135], v5, s[60:63], s78 offen offset:2048 sc1
    s_waitcnt vmcnt(12)
    v_xor_b32 v48, v136, v12
    v_xor_b32 v49, v137, v13
    v_xor_b32 v50, v138, v14
    v_xor_b32 v51, v139, v15
    v_xor_b32 v52, v140, v12
    v_xor_b32 v53, v141, v13
    v_xor_b32 v54, v142, v14
    v_xor_b32 v55, v143, v15
    v_xor_b32 v56, v144, v12
    v_xor_b32 v57, v145, v13
    v_xor_b32 v58, v146, v14
    v_xor_b32 v59, v147, v15
    v_xor_b32 v60, v148, v12
    v_xor_b32 v61, v149, v13
    v_xor_b32 v62, v150, v14
    v_xor_b32 v63, v151, v15
    v_or3_b32 v32, v48, v49, v50
    v_or3_b32 v33, v51, v52, v53
    v_or3_b32 v33, v33, v54, v55
    v_or3_b32 v32, v32, v56, v57
    v_or3_b32 v33, v33, v58, v59
    v_or3_b32 v32, v32, v60, v61
    v_or3_b32 v33, v33, v62, v63
    v_or_b32 v32, v32, v33
    v_and_b32 v32, s76, v32
    v_cmp_ne_u32 vcc, 0, v32
    s_nop 0
    s_cbranch_vccz L_y_11_done
    s_mov_b64 exec, vcc
    buffer_load_dwordx4 v[136:139], v5, s[60:63], s69 offen offset:0 sc1
    buffer_load_dwordx4 v[140:143], v5, s[60:63], s69 offen offset:2048 sc1
    buffer_load_dwordx4 v[144:147], v5, s[60:63], s78 offen offset:0 sc1
    buffer_load_dwordx4 v[148:151], v5, s[60:63], s78 offen offset:2048 sc1
    s_waitcnt vmcnt(12)
    v_xor_b32 v48, v152, v12
    v_xor_b32 v49, v153, v13
    v_xor_b32 v50, v154, v14
    v_xor_b32 v51, v155, v15
    v_xor_b32 v52, v156, v12
    v_xor_b32 v53, v157, v13
    v_xor_b32 v54, v158, v14
    v_xor_b32 v55, v159, v15
    v_xor_b32 v56, v160, v12
    v_xor_b32 v57, v161, v13
    v_xor_b32 v58, v162, v14
    v_xor_b32 v59, v163, v15
    v_xor_b32 v60, v164, v12
    v_xor_b32 v61, v165, v13
    v_xor_b32 v62, v166, v14
    v_xor_b32 v63, v167, v15
    v_or3_b32 v32, v48, v49, v50
    v_or3_b32 v33, v51, v52, v53
    v_or3_b32 v33, v33, v54, v55
    v_or3_b32 v32, v32, v56, v57
    v_or3_b32 v33, v33, v58, v59
    v_or3_b32 v32, v32, v60, v61
    v_or3_b32 v33, v33, v62, v63
    v_or_b32 v32, v32, v33
    v_and_b32 v32, s76, v32
    v_cmp_ne_u32 vcc, 0, v32
    s_nop 0
    s_cbranch_vccz L_y_11_done
    s_mov_b64 exec, vcc
    buffer_load_dwordx4 v[152:155], v5, s[60:63], s69 offen offset:0 sc1
    buffer_load_dwordx4 v[156:159], v5, s[60:63], s69 offen offset:2048 sc1
    buffer_load_dwordx4 v[160:163], v5, s[60:63], s78 offen offset:0 sc1
    buffer_load_dwordx4 v[164:167], v5, s[60:63], s78 offen offset:2048 sc1
    s_sub_u32 s100, s100, 1
    s_cmp_lg_u32 s100, 0
    s_cbranch_scc1 L_y_11
L_y_11_done:
    s_mov_b64 exec, -1
    v_lshlrev_b32 v34, 2, v0
    v_mov_b32 v35, 0
    ds_read_b32 v36, v35 offset:1624
    ds_read_b32 v7, v34 offset:0
    v_add_f32 v48, v48, v52
    v_add_f32 v49, v49, v53
    v_add_f32 v50, v50, v54
    v_add_f32 v51, v51, v55
    v_add_f32 v56, v56, v60
    v_add_f32 v57, v57, v61
    v_add_f32 v58, v58, v62
    v_add_f32 v59, v59, v63
    v_add_f32 v48, v48, v56
    v_add_f32 v49, v49, v57
    v_add_f32 v50, v50, v58
    v_add_f32 v51, v51, v59
    v_permlane32_swap_b32 v48, v49
    s_nop 0
    v_permlane32_swap_b32 v50, v51
    v_add_f32 v48, v48, v49
    v_add_f32 v50, v50, v51
    s_nop 1
    v_permlane16_swap_b32 v48, v50
    v_add_f32 v48, v48, v50
    s_nop 1
    v_add_f32_dpp v48, v48, v48 row_ror:8 row_mask:0xf bank_mask:0xf
    v_cvt_pk_bf16_f32 v48, v48, v48
    v_and_b32 v48, 0xffff0000, v48
    v_add_f32 v48, v48, v2
    v_cvt_pk_bf16_f32 v48, v48, v48
    v_and_b32 v48, 0xffff0000, v48
    s_mov_b32 s100, 0x800000
L_fb_12:
    s_waitcnt lgkmcnt(0)
    v_cmp_eq_u32 vcc, 0, v36
    s_nop 1
    s_cbranch_vccz L_fb_12_ok
    ds_read_b32 v36, v35 offset:1624
    ds_read_b32 v7, v34 offset:0
    s_sub_u32 s100, s100, 1
    s_cmp_lg_u32 s100, 0
    s_cbranch_scc1 L_fb_12
    s_waitcnt lgkmcnt(0)
L_fb_12_ok:
    v_add_f32 v48, v48, v7
    v_cvt_pk_bf16_f32 v48, v48, v48
    s_mov_b32 exec_lo, 0xff00ff
    s_mov_b32 exec_hi, 0xff00ff
    buffer_store_short v48, v6, s[52:55], 0 offen
    s_mov_b64 exec, -1
    s_cmp_lg_u32 s101, 0
    s_cbranch_scc1 L_fin
    v_mov_b32 v32, s14
    v_mov_b32 v33, 0
    s_mov_b64 exec, 1
    buffer_store_dword v32, v33, s[60:63], 0 offen
    v_mov_b32 v34, 1040384
    buffer_store_dword v32, v34, s[60:63], 0 offen
    s_mov_b64 exec, -1
    s_branch L_fin
L_fyb:
    buffer_load_dwordx4 v[84:87], v5, s[60:63], s56 offen offset:0 sc1
    buffer_load_dwordx4 v[88:91], v5, s[60:63], s56 offen offset:2048 sc1
    buffer_load_dwordx4 v[92:95], v5, s[60:63], s41 offen offset:0 sc1
    buffer_load_dwordx4 v[96:99], v5, s[60:63], s41 offen offset:2048 sc1
    buffer_load_dwordx4 v[100:103], v7, s[60:63], s42 offen offset:0 sc1
    s_sleep 4
    buffer_load_dwordx4 v[104:107], v5, s[60:63], s56 offen offset:0 sc1
    buffer_load_dwordx4 v[108:111], v5, s[60:63], s56 offen offset:2048 sc1
    buffer_load_dwordx4 v[112:115], v5, s[60:63], s41 offen offset:0 sc1
    buffer_load_dwordx4 v[116:119], v5, s[60:63], s41 offen offset:2048 sc1
    buffer_load_dwordx4 v[120:123], v7, s[60:63], s42 offen offset:0 sc1
    s_sleep 4
    buffer_load_dwordx4 v[124:127], v5, s[60:63], s56 offen offset:0 sc1
    buffer_load_dwordx4 v[128:131], v5, s[60:63], s56 offen offset:2048 sc1
    buffer_load_dwordx4 v[132:135], v5, s[60:63], s41 offen offset:0 sc1
    buffer_load_dwordx4 v[136:139], v5, s[60:63], s41 offen offset:2048 sc1
    buffer_load_dwordx4 v[140:143], v7, s[60:63], s42 offen offset:0 sc1
    s_mov_b32 s100, 1048576
L_fyb_13:
    s_waitcnt vmcnt(10)
    v_xor_b32 v64, v84, v12
    v_xor_b32 v65, v85, v13
    v_xor_b32 v66, v86, v14
    v_xor_b32 v67, v87, v15
    v_xor_b32 v68, v88, v12
    v_xor_b32 v69, v89, v13
    v_xor_b32 v70, v90, v14
    v_xor_b32 v71, v91, v15
    v_xor_b32 v72, v92, v12
    v_xor_b32 v73, v93, v13
    v_xor_b32 v74, v94, v14
    v_xor_b32 v75, v95, v15
    v_xor_b32 v76, v96, v12
    v_xor_b32 v77, v97, v13
    v_xor_b32 v78, v98, v14
    v_xor_b32 v79, v99, v15
    v_xor_b32 v80, v100, v12
    v_xor_b32 v81, v101, v13
    v_xor_b32 v82, v102, v14
    v_xor_b32 v83, v103, v15
    v_or3_b32 v32, v64, v65, v66
    v_or3_b32 v33, v67, v68, v69
    v_or3_b32 v33, v33, v70, v71
    v_or3_b32 v32, v32, v72, v73
    v_or3_b32 v33, v33, v74, v75
    v_or3_b32 v32, v32, v76, v77
    v_or3_b32 v33, v33, v78, v79
    v_or3_b32 v32, v32, v80, v81
    v_or3_b32 v33, v33, v82, v83
    v_or_b32 v32, v32, v33
    v_and_b32 v32, s76, v32
    v_cmp_ne_u32 vcc, 0, v32
    s_nop 0
    s_cbranch_vccz L_fyb_13_done
    s_mov_b64 exec, vcc
    buffer_load_dwordx4 v[84:87], v5, s[60:63], s56 offen offset:0 sc1
    buffer_load_dwordx4 v[88:91], v5, s[60:63], s56 offen offset:2048 sc1
    buffer_load_dwordx4 v[92:95], v5, s[60:63], s41 offen offset:0 sc1
    buffer_load_dwordx4 v[96:99], v5, s[60:63], s41 offen offset:2048 sc1
    buffer_load_dwordx4 v[100:103], v7, s[60:63], s42 offen offset:0 sc1
    s_waitcnt vmcnt(10)
    v_xor_b32 v64, v104, v12
    v_xor_b32 v65, v105, v13
    v_xor_b32 v66, v106, v14
    v_xor_b32 v67, v107, v15
    v_xor_b32 v68, v108, v12
    v_xor_b32 v69, v109, v13
    v_xor_b32 v70, v110, v14
    v_xor_b32 v71, v111, v15
    v_xor_b32 v72, v112, v12
    v_xor_b32 v73, v113, v13
    v_xor_b32 v74, v114, v14
    v_xor_b32 v75, v115, v15
    v_xor_b32 v76, v116, v12
    v_xor_b32 v77, v117, v13
    v_xor_b32 v78, v118, v14
    v_xor_b32 v79, v119, v15
    v_xor_b32 v80, v120, v12
    v_xor_b32 v81, v121, v13
    v_xor_b32 v82, v122, v14
    v_xor_b32 v83, v123, v15
    v_or3_b32 v32, v64, v65, v66
    v_or3_b32 v33, v67, v68, v69
    v_or3_b32 v33, v33, v70, v71
    v_or3_b32 v32, v32, v72, v73
    v_or3_b32 v33, v33, v74, v75
    v_or3_b32 v32, v32, v76, v77
    v_or3_b32 v33, v33, v78, v79
    v_or3_b32 v32, v32, v80, v81
    v_or3_b32 v33, v33, v82, v83
    v_or_b32 v32, v32, v33
    v_and_b32 v32, s76, v32
    v_cmp_ne_u32 vcc, 0, v32
    s_nop 0
    s_cbranch_vccz L_fyb_13_done
    s_mov_b64 exec, vcc
    buffer_load_dwordx4 v[104:107], v5, s[60:63], s56 offen offset:0 sc1
    buffer_load_dwordx4 v[108:111], v5, s[60:63], s56 offen offset:2048 sc1
    buffer_load_dwordx4 v[112:115], v5, s[60:63], s41 offen offset:0 sc1
    buffer_load_dwordx4 v[116:119], v5, s[60:63], s41 offen offset:2048 sc1
    buffer_load_dwordx4 v[120:123], v7, s[60:63], s42 offen offset:0 sc1
    s_waitcnt vmcnt(10)
    v_xor_b32 v64, v124, v12
    v_xor_b32 v65, v125, v13
    v_xor_b32 v66, v126, v14
    v_xor_b32 v67, v127, v15
    v_xor_b32 v68, v128, v12
    v_xor_b32 v69, v129, v13
    v_xor_b32 v70, v130, v14
    v_xor_b32 v71, v131, v15
    v_xor_b32 v72, v132, v12
    v_xor_b32 v73, v133, v13
    v_xor_b32 v74, v134, v14
    v_xor_b32 v75, v135, v15
    v_xor_b32 v76, v136, v12
    v_xor_b32 v77, v137, v13
    v_xor_b32 v78, v138, v14
    v_xor_b32 v79, v139, v15
    v_xor_b32 v80, v140, v12
    v_xor_b32 v81, v141, v13
    v_xor_b32 v82, v142, v14
    v_xor_b32 v83, v143, v15
    v_or3_b32 v32, v64, v65, v66
    v_or3_b32 v33, v67, v68, v69
    v_or3_b32 v33, v33, v70, v71
    v_or3_b32 v32, v32, v72, v73
    v_or3_b32 v33, v33, v74, v75
    v_or3_b32 v32, v32, v76, v77
    v_or3_b32 v33, v33, v78, v79
    v_or3_b32 v32, v32, v80, v81
    v_or3_b32 v33, v33, v82, v83
    v_or_b32 v32, v32, v33
    v_and_b32 v32, s76, v32
    v_cmp_ne_u32 vcc, 0, v32
    s_nop 0
    s_cbranch_vccz L_fyb_13_done
    s_mov_b64 exec, vcc
    buffer_load_dwordx4 v[124:127], v5, s[60:63], s56 offen offset:0 sc1
    buffer_load_dwordx4 v[128:131], v5, s[60:63], s56 offen offset:2048 sc1
    buffer_load_dwordx4 v[132:135], v5, s[60:63], s41 offen offset:0 sc1
    buffer_load_dwordx4 v[136:139], v5, s[60:63], s41 offen offset:2048 sc1
    buffer_load_dwordx4 v[140:143], v7, s[60:63], s42 offen offset:0 sc1
    s_sub_u32 s100, s100, 1
    s_cmp_lg_u32 s100, 0
    s_cbranch_scc1 L_fyb_13
L_fyb_13_done:
    s_mov_b64 exec, -1
    v_cmp_gt_u32 vcc, 32, v0
    s_nop 1
    v_cndmask_b32 v80, 0, v80, vcc
    v_cndmask_b32 v81, 0, v81, vcc
    v_cndmask_b32 v82, 0, v82, vcc
    v_cndmask_b32 v83, 0, v83, vcc
    v_add_f32 v64, v64, v68
    v_add_f32 v65, v65, v69
    v_add_f32 v66, v66, v70
    v_add_f32 v67, v67, v71
    v_add_f32 v72, v72, v76
    v_add_f32 v73, v73, v77
    v_add_f32 v74, v74, v78
    v_add_f32 v75, v75, v79
    v_add_f32 v64, v64, v72
    v_add_f32 v65, v65, v73
    v_add_f32 v66, v66, v74
    v_add_f32 v67, v67, v75
    v_add_f32 v64, v64, v80
    v_add_f32 v65, v65, v81
    v_add_f32 v66, v66, v82
    v_add_f32 v67, v67, v83
    v_permlane32_swap_b32 v64, v65
    s_nop 0
    v_permlane32_swap_b32 v66, v67
    v_add_f32 v64, v64, v65
    v_add_f32 v66, v66, v67
    s_nop 1
    v_permlane16_swap_b32 v64, v66
    v_add_f32 v64, v64, v66
    s_nop 1
    v_add_f32_dpp v64, v64, v64 row_ror:8 row_mask:0xf bank_mask:0xf
    v_cvt_pk_bf16_f32 v64, v64, v64
    v_and_b32 v64, 0xffff0000, v64
    v_mov_b32 v7, v64
    v_lshlrev_b32 v34, 2, v0
    v_mov_b32 v35, 0
    v_mov_b32 v36, 1
    ds_write_b32 v34, v7 offset:0
    ds_write_b32 v35, v36 offset:1624
    s_branch L_fin
L_wo:
    s_mul_i32 s71, s66, 147456
    s_lshl_b32 s73, s57, 7
    s_add_u32 s71, s71, s73
    buffer_load_dwordx4 v[104:107], v3, s[44:47], s71 offen nt
    s_add_u32 s71, s71, 9216
    buffer_load_dwordx4 v[108:111], v3, s[44:47], s71 offen nt
    s_add_u32 s71, s71, 9216
    buffer_load_dwordx4 v[112:115], v3, s[44:47], s71 offen nt
    s_add_u32 s71, s71, 9216
    buffer_load_dwordx4 v[116:119], v3, s[44:47], s71 offen nt
    s_add_u32 s71, s71, 9216
    buffer_load_dwordx4 v[120:123], v3, s[44:47], s71 offen nt
    s_add_u32 s71, s71, 9216
    buffer_load_dwordx4 v[124:127], v3, s[44:47], s71 offen nt
    s_add_u32 s71, s71, 9216
    buffer_load_dwordx4 v[128:131], v3, s[44:47], s71 offen nt
    s_add_u32 s71, s71, 9216
    buffer_load_dwordx4 v[132:135], v3, s[44:47], s71 offen nt
    s_add_u32 s71, s71, 9216
    s_waitcnt vmcnt(7)
    buffer_load_dwordx4 v[136:139], v3, s[44:47], s71 offen nt
    s_add_u32 s71, s71, 9216
    s_waitcnt vmcnt(7)
    buffer_load_dwordx4 v[140:143], v3, s[44:47], s71 offen nt
    s_add_u32 s71, s71, 9216
    s_waitcnt vmcnt(7)
    buffer_load_dwordx4 v[144:147], v3, s[44:47], s71 offen nt
    s_add_u32 s71, s71, 9216
    s_waitcnt vmcnt(7)
    buffer_load_dwordx4 v[148:151], v3, s[44:47], s71 offen nt
    s_add_u32 s71, s71, 9216
    s_waitcnt vmcnt(7)
    buffer_load_dwordx4 v[152:155], v3, s[44:47], s71 offen nt
    s_add_u32 s71, s71, 9216
    s_waitcnt vmcnt(7)
    buffer_load_dwordx4 v[156:159], v3, s[44:47], s71 offen nt
    s_add_u32 s71, s71, 9216
    s_waitcnt vmcnt(7)
    buffer_load_dwordx4 v[160:163], v3, s[44:47], s71 offen nt
    s_add_u32 s71, s71, 9216
    s_waitcnt vmcnt(7)
    buffer_load_dwordx4 v[164:167], v3, s[44:47], s71 offen nt
    s_waitcnt vmcnt(0)
    s_mov_b32 s73, 40960
    v_lshrrev_b32 v32, 3, v45
    v_lshl_add_u32 v32, v32, 2, v46
    v_and_b32 v33, 7, v45
    v_lshlrev_b32 v33, 4, v33
    v_lshl_add_u32 v32, v32, 7, v33
    v_add_u32 v32, s73, v32
    ds_write_b128 v32, v[104:107] offset:0
    ds_write_b128 v32, v[108:111] offset:1024
    ds_write_b128 v32, v[112:115] offset:2048
    ds_write_b128 v32, v[116:119] offset:3072
    ds_write_b128 v32, v[120:123] offset:4096
    ds_write_b128 v32, v[124:127] offset:5120
    ds_write_b128 v32, v[128:131] offset:6144
    ds_write_b128 v32, v[132:135] offset:7168
    ds_write_b128 v32, v[136:139] offset:8192
    ds_write_b128 v32, v[140:143] offset:9216
    ds_write_b128 v32, v[144:147] offset:10240
    ds_write_b128 v32, v[148:151] offset:11264
    ds_write_b128 v32, v[152:155] offset:12288
    ds_write_b128 v32, v[156:159] offset:13312
    ds_write_b128 v32, v[160:163] offset:14336
    ds_write_b128 v32, v[164:167] offset:15360
    s_nop 1
    s_setpc_b64 s[58:59]
L_f1:
    v_lshlrev_b32 v44, 7, v46
    v_lshl_add_u32 v44, v45, 4, v44
    s_and_b32 s72, s56, 3
    s_mul_i32 s73, s72, 288
    v_add_u32 v47, s73, v15
    s_mul_i32 s68, s72, 1327104
    s_lshr_b32 s73, s56, 2
    s_lshl_b32 s73, s73, 7
    s_add_u32 s68, s68, s73
    buffer_load_dwordx4 v[48:51], v5, s[32:35], s68 offen nt
    buffer_load_dwordx4 v[52:55], v5, s[36:39], s68 offen nt
    s_add_u32 s68, s68, 73728
    buffer_load_dwordx4 v[56:59], v5, s[32:35], s68 offen nt
    buffer_load_dwordx4 v[60:63], v5, s[36:39], s68 offen nt
    s_add_u32 s68, s68, 73728
    buffer_load_dwordx4 v[64:67], v5, s[32:35], s68 offen nt
    v_mov_b32 v33, 0
    s_mov_b32 s100, 0x800000
L_z_14:
    ds_read_b32 v32, v33 offset:1604
    ds_read_b32 v12, v47 offset:256
    ds_read_b32 v13, v47 offset:512
    s_waitcnt lgkmcnt(0)
    v_cmp_eq_u32 vcc, 0, v32
    s_nop 1
    s_cbranch_vccz L_z_14_done
    s_sleep 1
    s_sub_u32 s100, s100, 1
    s_cmp_lg_u32 s100, 0
    s_cbranch_scc1 L_z_14
L_z_14_done:
    s_cmp_eq_u32 s3, 9
    s_cselect_b64 vcc, -1, 0
    v_mov_b32_dpp v32, v12 row_newbcast:0 row_mask:0xf bank_mask:0xf
    v_perm_b32 v24, v32, v32, v8
    v_perm_b32 v25, v32, v32, v9
    v_perm_b32 v26, v32, v32, v10
    v_perm_b32 v27, v32, v32, v11
    v_mov_b32_dpp v32, v12 row_newbcast:1 row_mask:0xf bank_mask:0xf
    v_perm_b32 v28, v32, v32, v8
    v_perm_b32 v29, v32, v32, v9
    v_perm_b32 v30, v32, v32, v10
    v_perm_b32 v31, v32, v32, v11
    s_waitcnt vmcnt(4)
    s_cbranch_vccz L_nb_15
    s_waitcnt vmcnt(0)
L_nb_15:
    buffer_load_dwordx4 v[68:71], v5, s[36:39], s68 offen nt
    s_add_u32 s68, s68, 73728
    buffer_load_dwordx4 v[72:75], v5, s[32:35], s68 offen nt
    buffer_load_dwordx4 v[76:79], v5, s[36:39], s68 offen nt
    s_add_u32 s68, s68, 73728
    buffer_load_dwordx4 v[80:83], v5, s[32:35], s68 offen nt
    buffer_load_dwordx4 v[84:87], v5, s[36:39], s68 offen nt
    s_add_u32 s68, s68, 73728
    buffer_load_dwordx4 v[88:91], v5, s[32:35], s68 offen nt
    v_mfma_f32_16x16x32_bf16 v[16:19], v[24:27], v[48:51], 0
    s_waitcnt vmcnt(9)
    s_cbranch_vccz L_nb_16
    s_waitcnt vmcnt(4)
L_nb_16:
    buffer_load_dwordx4 v[48:51], v5, s[36:39], s68 offen nt
    s_add_u32 s68, s68, 73728
    v_mfma_f32_16x16x32_bf16 v[20:23], v[24:27], v[52:55], 0
    v_mov_b32_dpp v32, v12 row_newbcast:2 row_mask:0xf bank_mask:0xf
    v_perm_b32 v24, v32, v32, v8
    v_perm_b32 v25, v32, v32, v9
    v_perm_b32 v26, v32, v32, v10
    v_perm_b32 v27, v32, v32, v11
    s_waitcnt vmcnt(9)
    s_cbranch_vccz L_nb_17
    s_waitcnt vmcnt(4)
L_nb_17:
    buffer_load_dwordx4 v[52:55], v5, s[32:35], s68 offen nt
    v_mfma_f32_16x16x32_bf16 v[16:19], v[28:31], v[56:59], v[16:19]
    s_waitcnt vmcnt(9)
    s_cbranch_vccz L_nb_18
    s_waitcnt vmcnt(4)
L_nb_18:
    buffer_load_dwordx4 v[56:59], v5, s[36:39], s68 offen nt
    s_add_u32 s68, s68, 73728
    v_mfma_f32_16x16x32_bf16 v[20:23], v[28:31], v[60:63], v[20:23]
    v_mov_b32_dpp v32, v12 row_newbcast:3 row_mask:0xf bank_mask:0xf
    v_perm_b32 v28, v32, v32, v8
    v_perm_b32 v29, v32, v32, v9
    v_perm_b32 v30, v32, v32, v10
    v_perm_b32 v31, v32, v32, v11
    s_waitcnt vmcnt(9)
    s_cbranch_vccz L_nb_19
    s_waitcnt vmcnt(4)
L_nb_19:
    buffer_load_dwordx4 v[60:63], v5, s[32:35], s68 offen nt
    v_mfma_f32_16x16x32_bf16 v[16:19], v[24:27], v[64:67], v[16:19]
    s_waitcnt vmcnt(9)
    s_cbranch_vccz L_nb_20
    s_waitcnt vmcnt(4)
L_nb_20:
    buffer_load_dwordx4 v[64:67], v5, s[36:39], s68 offen nt
    s_add_u32 s68, s68, 73728
    v_mfma_f32_16x16x32_bf16 v[20:23], v[24:27], v[68:71], v[20:23]
    v_mov_b32_dpp v32, v12 row_newbcast:4 row_mask:0xf bank_mask:0xf
    v_perm_b32 v24, v32, v32, v8
    v_perm_b32 v25, v32, v32, v9
    v_perm_b32 v26, v32, v32, v10
    v_perm_b32 v27, v32, v32, v11
    s_waitcnt vmcnt(9)
    s_cbranch_vccz L_nb_21
    s_waitcnt vmcnt(4)
L_nb_21:
    buffer_load_dwordx4 v[68:71], v5, s[32:35], s68 offen nt
    v_mfma_f32_16x16x32_bf16 v[16:19], v[28:31], v[72:75], v[16:19]
    s_waitcnt vmcnt(9)
    s_cbranch_vccz L_nb_22
    s_waitcnt vmcnt(4)
L_nb_22:
    buffer_load_dwordx4 v[72:75], v5, s[36:39], s68 offen nt
    s_add_u32 s68, s68, 73728
    v_mfma_f32_16x16x32_bf16 v[20:23], v[28:31], v[76:79], v[20:23]
    v_mov_b32_dpp v32, v12 row_newbcast:5 row_mask:0xf bank_mask:0xf
    v_perm_b32 v28, v32, v32, v8
    v_perm_b32 v29, v32, v32, v9
    v_perm_b32 v30, v32, v32, v10
    v_perm_b32 v31, v32, v32, v11
    s_waitcnt vmcnt(9)
    s_cbranch_vccz L_nb_23
    s_waitcnt vmcnt(4)
L_nb_23:
    buffer_load_dwordx4 v[76:79], v5, s[32:35], s68 offen nt
    v_mfma_f32_16x16x32_bf16 v[16:19], v[24:27], v[80:83], v[16:19]
    s_waitcnt vmcnt(9)
    s_cbranch_vccz L_nb_24
    s_waitcnt vmcnt(4)
L_nb_24:
    buffer_load_dwordx4 v[80:83], v5, s[36:39], s68 offen nt
    s_add_u32 s68, s68, 73728
    v_mfma_f32_16x16x32_bf16 v[20:23], v[24:27], v[84:87], v[20:23]
    v_mov_b32_dpp v32, v12 row_newbcast:6 row_mask:0xf bank_mask:0xf
    v_perm_b32 v24, v32, v32, v8
    v_perm_b32 v25, v32, v32, v9
    v_perm_b32 v26, v32, v32, v10
    v_perm_b32 v27, v32, v32, v11
    s_waitcnt vmcnt(9)
    s_cbranch_vccz L_nb_25
    s_waitcnt vmcnt(4)
L_nb_25:
    buffer_load_dwordx4 v[84:87], v5, s[32:35], s68 offen nt
    v_mfma_f32_16x16x32_bf16 v[16:19], v[28:31], v[88:91], v[16:19]
    s_waitcnt vmcnt(9)
    s_cbranch_vccz L_nb_26
    s_waitcnt vmcnt(4)
L_nb_26:
    buffer_load_dwordx4 v[88:91], v5, s[36:39], s68 offen nt
    s_add_u32 s68, s68, 73728
    v_mfma_f32_16x16x32_bf16 v[20:23], v[28:31], v[48:51], v[20:23]
    v_mov_b32_dpp v32, v12 row_newbcast:7 row_mask:0xf bank_mask:0xf
    v_perm_b32 v28, v32, v32, v8
    v_perm_b32 v29, v32, v32, v9
    v_perm_b32 v30, v32, v32, v10
    v_perm_b32 v31, v32, v32, v11
    s_waitcnt vmcnt(9)
    s_cbranch_vccz L_nb_27
    s_waitcnt vmcnt(4)
L_nb_27:
    buffer_load_dwordx4 v[48:51], v5, s[32:35], s68 offen nt
    v_mfma_f32_16x16x32_bf16 v[16:19], v[24:27], v[52:55], v[16:19]
    s_waitcnt vmcnt(9)
    s_cbranch_vccz L_nb_28
    s_waitcnt vmcnt(4)
L_nb_28:
    buffer_load_dwordx4 v[52:55], v5, s[36:39], s68 offen nt
    s_add_u32 s68, s68, 73728
    v_mfma_f32_16x16x32_bf16 v[20:23], v[24:27], v[56:59], v[20:23]
    v_mov_b32_dpp v32, v12 row_newbcast:8 row_mask:0xf bank_mask:0xf
    v_perm_b32 v24, v32, v32, v8
    v_perm_b32 v25, v32, v32, v9
    v_perm_b32 v26, v32, v32, v10
    v_perm_b32 v27, v32, v32, v11
    s_waitcnt vmcnt(9)
    s_cbranch_vccz L_nb_29
    s_waitcnt vmcnt(4)
L_nb_29:
    buffer_load_dwordx4 v[56:59], v5, s[32:35], s68 offen nt
    v_mfma_f32_16x16x32_bf16 v[16:19], v[28:31], v[60:63], v[16:19]
    s_waitcnt vmcnt(9)
    s_cbranch_vccz L_nb_30
    s_waitcnt vmcnt(4)
L_nb_30:
    buffer_load_dwordx4 v[60:63], v5, s[36:39], s68 offen nt
    s_add_u32 s68, s68, 73728
    v_mfma_f32_16x16x32_bf16 v[20:23], v[28:31], v[64:67], v[20:23]
    v_mov_b32_dpp v32, v12 row_newbcast:9 row_mask:0xf bank_mask:0xf
    v_perm_b32 v28, v32, v32, v8
    v_perm_b32 v29, v32, v32, v9
    v_perm_b32 v30, v32, v32, v10
    v_perm_b32 v31, v32, v32, v11
    s_waitcnt vmcnt(9)
    s_cbranch_vccz L_nb_31
    s_waitcnt vmcnt(4)
L_nb_31:
    buffer_load_dwordx4 v[64:67], v5, s[32:35], s68 offen nt
    v_mfma_f32_16x16x32_bf16 v[16:19], v[24:27], v[68:71], v[16:19]
    s_waitcnt vmcnt(9)
    s_cbranch_vccz L_nb_32
    s_waitcnt vmcnt(4)
L_nb_32:
    buffer_load_dwordx4 v[68:71], v5, s[36:39], s68 offen nt
    s_add_u32 s68, s68, 73728
    v_mfma_f32_16x16x32_bf16 v[20:23], v[24:27], v[72:75], v[20:23]
    v_mov_b32_dpp v32, v12 row_newbcast:10 row_mask:0xf bank_mask:0xf
    v_perm_b32 v24, v32, v32, v8
    v_perm_b32 v25, v32, v32, v9
    v_perm_b32 v26, v32, v32, v10
    v_perm_b32 v27, v32, v32, v11
    s_waitcnt vmcnt(9)
    s_cbranch_vccz L_nb_33
    s_waitcnt vmcnt(4)
L_nb_33:
    buffer_load_dwordx4 v[72:75], v5, s[32:35], s68 offen nt
    v_mfma_f32_16x16x32_bf16 v[16:19], v[28:31], v[76:79], v[16:19]
    s_waitcnt vmcnt(9)
    s_cbranch_vccz L_nb_34
    s_waitcnt vmcnt(4)
L_nb_34:
    buffer_load_dwordx4 v[76:79], v5, s[36:39], s68 offen nt
    s_add_u32 s68, s68, 73728
    v_mfma_f32_16x16x32_bf16 v[20:23], v[28:31], v[80:83], v[20:23]
    v_mov_b32_dpp v32, v12 row_newbcast:11 row_mask:0xf bank_mask:0xf
    v_perm_b32 v28, v32, v32, v8
    v_perm_b32 v29, v32, v32, v9
    v_perm_b32 v30, v32, v32, v10
    v_perm_b32 v31, v32, v32, v11
    s_waitcnt vmcnt(9)
    s_cbranch_vccz L_nb_35
    s_waitcnt vmcnt(4)
L_nb_35:
    buffer_load_dwordx4 v[80:83], v5, s[32:35], s68 offen nt
    v_mfma_f32_16x16x32_bf16 v[16:19], v[24:27], v[84:87], v[16:19]
    s_waitcnt vmcnt(9)
    s_cbranch_vccz L_nb_36
    s_waitcnt vmcnt(4)
L_nb_36:
    buffer_load_dwordx4 v[84:87], v5, s[36:39], s68 offen nt
    s_add_u32 s68, s68, 73728
    v_mfma_f32_16x16x32_bf16 v[20:23], v[24:27], v[88:91], v[20:23]
    v_mov_b32_dpp v32, v12 row_newbcast:12 row_mask:0xf bank_mask:0xf
    v_perm_b32 v24, v32, v32, v8
    v_perm_b32 v25, v32, v32, v9
    v_perm_b32 v26, v32, v32, v10
    v_perm_b32 v27, v32, v32, v11
    s_waitcnt vmcnt(9)
    s_cbranch_vccz L_nb_37
    s_waitcnt vmcnt(4)
L_nb_37:
    buffer_load_dwordx4 v[88:91], v5, s[32:35], s68 offen nt
    v_mfma_f32_16x16x32_bf16 v[16:19], v[28:31], v[48:51], v[16:19]
    s_waitcnt vmcnt(9)
    s_cbranch_vccz L_nb_38
    s_waitcnt vmcnt(4)
L_nb_38:
    buffer_load_dwordx4 v[48:51], v5, s[36:39], s68 offen nt
    s_add_u32 s68, s68, 73728
    v_mfma_f32_16x16x32_bf16 v[20:23], v[28:31], v[52:55], v[20:23]
    v_mov_b32_dpp v32, v12 row_newbcast:13 row_mask:0xf bank_mask:0xf
    v_perm_b32 v28, v32, v32, v8
    v_perm_b32 v29, v32, v32, v9
    v_perm_b32 v30, v32, v32, v10
    v_perm_b32 v31, v32, v32, v11
    s_waitcnt vmcnt(9)
    s_cbranch_vccz L_nb_39
    s_waitcnt vmcnt(4)
L_nb_39:
    buffer_load_dwordx4 v[52:55], v5, s[32:35], s68 offen nt
    v_mfma_f32_16x16x32_bf16 v[16:19], v[24:27], v[56:59], v[16:19]
    s_waitcnt vmcnt(9)
    s_cbranch_vccz L_nb_40
    s_waitcnt vmcnt(4)
L_nb_40:
    buffer_load_dwordx4 v[56:59], v5, s[36:39], s68 offen nt
    v_mfma_f32_16x16x32_bf16 v[20:23], v[24:27], v[60:63], v[20:23]
    v_mov_b32_dpp v32, v12 row_newbcast:14 row_mask:0xf bank_mask:0xf
    v_perm_b32 v24, v32, v32, v8
    v_perm_b32 v25, v32, v32, v9
    v_perm_b32 v26, v32, v32, v10
    v_perm_b32 v27, v32, v32, v11
    s_waitcnt vmcnt(9)
    v_mfma_f32_16x16x32_bf16 v[16:19], v[28:31], v[64:67], v[16:19]
    s_waitcnt vmcnt(8)
    v_mfma_f32_16x16x32_bf16 v[20:23], v[28:31], v[68:71], v[20:23]
    v_mov_b32_dpp v32, v12 row_newbcast:15 row_mask:0xf bank_mask:0xf
    v_perm_b32 v28, v32, v32, v8
    v_perm_b32 v29, v32, v32, v9
    v_perm_b32 v30, v32, v32, v10
    v_perm_b32 v31, v32, v32, v11
    s_waitcnt vmcnt(7)
    v_mfma_f32_16x16x32_bf16 v[16:19], v[24:27], v[72:75], v[16:19]
    s_waitcnt vmcnt(6)
    v_mfma_f32_16x16x32_bf16 v[20:23], v[24:27], v[76:79], v[20:23]
    v_mov_b32_dpp v32, v13 row_newbcast:0 row_mask:0xf bank_mask:0xf
    v_perm_b32 v24, v32, v32, v8
    v_perm_b32 v25, v32, v32, v9
    v_perm_b32 v26, v32, v32, v10
    v_perm_b32 v27, v32, v32, v11
    s_waitcnt vmcnt(5)
    v_mfma_f32_16x16x32_bf16 v[16:19], v[28:31], v[80:83], v[16:19]
    s_waitcnt vmcnt(4)
    v_mfma_f32_16x16x32_bf16 v[20:23], v[28:31], v[84:87], v[20:23]
    v_mov_b32_dpp v32, v13 row_newbcast:1 row_mask:0xf bank_mask:0xf
    v_perm_b32 v28, v32, v32, v8
    v_perm_b32 v29, v32, v32, v9
    v_perm_b32 v30, v32, v32, v10
    v_perm_b32 v31, v32, v32, v11
    s_waitcnt vmcnt(3)
    v_mfma_f32_16x16x32_bf16 v[16:19], v[24:27], v[88:91], v[16:19]
    s_waitcnt vmcnt(2)
    v_mfma_f32_16x16x32_bf16 v[20:23], v[24:27], v[48:51], v[20:23]
    s_waitcnt vmcnt(1)
    v_mfma_f32_16x16x32_bf16 v[16:19], v[28:31], v[52:55], v[16:19]
    s_waitcnt vmcnt(0)
    v_mfma_f32_16x16x32_bf16 v[20:23], v[28:31], v[56:59], v[20:23]
    s_nop 5
    v_permlane32_swap_b32 v16, v18
    v_permlane32_swap_b32 v17, v19
    s_nop 0
    v_add_f32_dpp v16, v18, v16 row_ror:8 row_mask:0xf bank_mask:0xf
    v_add_f32_dpp v17, v19, v17 row_ror:8 row_mask:0xf bank_mask:0xf
    v_permlane32_swap_b32 v20, v22
    v_permlane32_swap_b32 v21, v23
    s_nop 0
    v_add_f32_dpp v20, v22, v20 row_ror:8 row_mask:0xf bank_mask:0xf
    v_add_f32_dpp v21, v23, v21 row_ror:8 row_mask:0xf bank_mask:0xf
    s_lshl_b32 s72, s56, 10
    s_add_u32 s72, s72, 524288
    v_mov_b32 v32, v16
    v_mov_b32 v33, v20
    v_mov_b32 v34, s14
    v_mov_b32 v35, s15
    v_mov_b32 v36, v17
    v_mov_b32 v37, v21
    v_mov_b32 v38, s14
    v_mov_b32 v39, s15
    s_mov_b32 exec_lo, 0xff00ff
    s_mov_b32 exec_hi, 0xff00ff
    s_lshr_b32 s73, s56, 2
    s_xor_b32 s73, s73, s56
    s_and_b32 s73, s73, 3
    s_cmp_eq_u32 s73, 0
    s_cbranch_scc1 L_own_41
    buffer_store_dwordx4 v[32:35], v44, s[60:63], s72 offen offset:0 sc1
    buffer_store_dwordx4 v[36:39], v44, s[60:63], s72 offen offset:512 sc1
    s_mov_b64 exec, -1
    s_nop 1
    s_setpc_b64 s[58:59]
L_own_41:
    s_sub_u32 s73, s3, 8
    s_lshl_b32 s73, s73, 9
    s_add_u32 s73, s73, 2048
    v_lshrrev_b32 v47, 1, v44
    v_add_u32 v47, s73, v47
    ds_write_b64 v47, v[32:33] offset:0
    ds_write_b64 v47, v[36:37] offset:256
    s_mov_b64 exec, -1
    v_lshlrev_b32 v47, 3, v0
    v_add_u32 v47, s73, v47
    ds_read_b64 v[16:17], v47
    v_mov_b32 v48, 0
    v_mov_b32 v49, 0
    v_mov_b32 v52, 0
    v_mov_b32 v53, 0
    v_mov_b32 v56, 0
    v_mov_b32 v57, 0
    v_mov_b32 v60, 0
    v_mov_b32 v61, 0
    s_and_b32 s73, s56, 3
    s_lshl_b32 s73, s73, 4
    s_mov_b32 s74, 0xffff
    s_mov_b32 s75, 0
    s_lshl_b64 s[74:75], s[74:75], s73
    s_not_b64 s[76:77], s[74:75]
    s_mov_b64 exec, -1
    s_lshr_b32 s72, s56, 2
    s_xor_b32 s73, s72, s56
    s_and_b32 s73, s73, 3
    s_mov_b64 s[70:71], s[76:77]
    s_lshl_b32 s73, s72, 12
    s_add_u32 s73, s73, 524288
    s_lshl_b32 s74, s72, 8
    s_add_u32 s74, s74, 1007616
    v_lshlrev_b32 v44, 10, v46
    v_lshl_add_u32 v44, v45, 4, v44
    s_mov_b32 s76, 0xffff
    v_mov_b32 v24, s14
    v_lshrrev_b32 v25, 16, v24
    v_lshrrev_b32 v26, 24, v24
    v_add3_u32 v25, v25, v24, 21
    v_add3_u32 v26, v26, v24, 42
    v_add_u32 v27, 63, v24
    v_and_b32 v24, s76, v24
    v_and_b32 v25, s76, v25
    v_and_b32 v26, s76, v26
    v_and_b32 v27, s76, v27
    s_not_b32 s76, s76
    v_and_b32 v47, 1, v0
    v_cmp_eq_u32 vcc, 1, v47
    s_nop 1
    v_cndmask_b32 v24, v24, v25, vcc
    v_cndmask_b32 v26, v26, v27, vcc
    v_and_b32 v47, 2, v0
    v_cmp_eq_u32 vcc, 2, v47
    s_nop 1
    v_cndmask_b32 v24, v24, v26, vcc
    v_lshlrev_b32 v47, 2, v0
    s_mov_b64 exec, s[70:71]
    s_mov_b32 s100, 0x100000
L_gu_44:
    buffer_load_dwordx4 v[48:51], v44, s[60:63], s73 offen offset:0 sc1
    buffer_load_dwordx4 v[52:55], v44, s[60:63], s73 offen offset:256 sc1
    buffer_load_dwordx4 v[56:59], v44, s[60:63], s73 offen offset:512 sc1
    buffer_load_dwordx4 v[60:63], v44, s[60:63], s73 offen offset:768 sc1
    s_waitcnt vmcnt(0)
    v_xor_b32 v50, s14, v50
    v_xor_b32 v51, s15, v51
    v_xor_b32 v54, s14, v54
    v_xor_b32 v55, s15, v55
    v_xor_b32 v58, s14, v58
    v_xor_b32 v59, s15, v59
    v_xor_b32 v62, s14, v62
    v_xor_b32 v63, s15, v63
    v_or_b32 v28, v50, v51
    v_or3_b32 v28, v28, v54, v55
    v_or3_b32 v28, v28, v58, v59
    v_or3_b32 v28, v28, v62, v63
    v_cmp_ne_u32 vcc, 0, v28
    s_nop 0
    s_cbranch_vccz L_gu_44_done
    s_mov_b64 exec, vcc
    s_sleep 8
    s_sub_u32 s100, s100, 1
    s_cmp_lg_u32 s100, 0
    s_cbranch_scc1 L_gu_44
L_gu_44_done:
    s_mov_b64 exec, -1
    v_permlane32_swap_b32 v48, v56
    v_permlane32_swap_b32 v49, v57
    v_permlane32_swap_b32 v52, v60
    v_permlane32_swap_b32 v53, v61
    v_add_f32 v48, v48, v56
    v_add_f32 v49, v49, v57
    v_add_f32 v52, v52, v60
    v_add_f32 v53, v53, v61
    s_nop 0
    v_permlane16_swap_b32 v48, v52
    v_permlane16_swap_b32 v49, v53
    v_add_f32 v48, v48, v52
    v_add_f32 v49, v49, v53
    s_waitcnt lgkmcnt(0)
    v_add_f32 v48, v48, v16
    v_add_f32 v49, v49, v17
    v_cvt_pk_bf16_f32 v49, v48, v49
    v_lshlrev_b32 v48, 16, v49
    v_and_b32 v49, 0xffff0000, v49
    v_cmp_lt_f32 vcc, 0, v48
    s_nop 1
    v_cndmask_b32 v50, 0, 1.0, vcc
    v_mul_f32 v48, v48, v50
    v_mul_f32 v48, v48, v49
    v_cvt_pk_bf16_f32 v48, v48, v48
    v_and_or_b32 v48, v48, s76, v24
    buffer_store_dword v48, v47, s[60:63], s74 offen sc1
L_notowner_43:
    s_nop 1
    s_setpc_b64 s[58:59]
L_f2:
    v_and_b32 v17, 0x1f0, v1
    v_bfe_u32 v4, v0, 4, 1
    v_lshlrev_b32 v4, 8, v4
    v_bfe_u32 v32, v0, 0, 1
    v_lshl_add_u32 v4, v32, 7, v4
    v_bfe_u32 v32, v0, 1, 1
    v_lshl_add_u32 v4, v32, 4, v4
    v_bfe_u32 v32, v0, 2, 1
    v_lshl_add_u32 v4, v32, 3, v4
    v_bfe_u32 v32, v0, 3, 1
    v_lshl_add_u32 v4, v32, 2, v4
    s_sub_u32 s73, s3, 8
    s_lshl_b32 s73, s73, 9
    s_add_u32 s73, s73, 2048
    v_add_u32 v4, s73, v4
    s_mov_b32 s76, 0xffff
    v_mov_b32 v24, s14
    v_lshrrev_b32 v25, 16, v24
    v_lshrrev_b32 v26, 24, v24
    v_add3_u32 v25, v25, v24, 21
    v_add3_u32 v26, v26, v24, 42
    v_add_u32 v27, 63, v24
    v_and_b32 v24, s76, v24
    v_and_b32 v25, s76, v25
    v_and_b32 v26, s76, v26
    v_and_b32 v27, s76, v27
    v_lshrrev_b32 v5, 2, v45
    v_lshlrev_b32 v5, 7, v5
    v_lshl_add_u32 v5, v46, 5, v5
    v_and_b32 v32, 3, v45
    v_lshl_add_u32 v5, v32, 3, v5
    v_add_u32 v5, s73, v5
    v_lshlrev_b32 v7, 7, v46
    v_lshl_add_u32 v7, v45, 4, v7
    s_mul_i32 s72, s56, 7282
    s_lshr_b32 s72, s72, 16
    s_mul_i32 s73, s72, 9
    s_sub_u32 s73, s56, s73
    s_mul_i32 s68, s72, 147456
    s_lshl_b32 s74, s73, 7
    s_add_u32 s68, s68, s74
    s_mul_i32 s70, s73, 9216
    s_lshl_b32 s74, s72, 8
    s_add_u32 s70, s70, s74
    s_add_u32 s70, s70, 921600
    s_lshl_b32 s74, s72, 9
    s_add_u32 s74, s74, 1007616
    s_mov_b32 s100, 0x100000
L_h_45:
    buffer_load_dwordx4 v[48:51], v17, s[60:63], s74 offen sc1
    s_waitcnt vmcnt(0)
    v_xor_b32 v48, v48, v24
    v_xor_b32 v49, v49, v25
    v_xor_b32 v50, v50, v26
    v_xor_b32 v51, v51, v27
    v_or_b32 v32, v48, v49
    v_or3_b32 v32, v32, v50, v51
    v_and_b32 v32, s76, v32
    v_cmp_ne_u32 vcc, 0, v32
    s_nop 0
    s_cbranch_vccz L_h_45_done
    s_mov_b64 exec, vcc
    s_sleep 8
    s_sub_u32 s100, s100, 1
    s_cmp_lg_u32 s100, 0
    s_cbranch_scc1 L_h_45
L_h_45_done:
    s_mov_b64 exec, -1
    ds_write2_b32 v4, v48, v49 offset0:0 offset1:8
    ds_write2_b32 v4, v50, v51 offset0:16 offset1:24
    s_mov_b32 s76, 0xfff
    v_mov_b32 v12, s14
    v_lshrrev_b32 v13, 12, v12
    v_lshrrev_b32 v14, 24, v12
    v_add3_u32 v13, v13, v12, 21
    v_add3_u32 v14, v14, v12, 42
    v_add_u32 v15, 63, v12
    v_and_b32 v12, s76, v12
    v_and_b32 v13, s76, v13
    v_and_b32 v14, s76, v14
    v_and_b32 v15, s76, v15
    ds_read_b64 v[20:21], v5
    s_cmp_lg_u32 s3, 9
    s_cbranch_scc1 L_go_46
    v_mov_b32 v33, 0
    s_mov_b32 s100, 0x800000
L_trig_47:
    ds_read_b32 v32, v33 offset:1616
    s_waitcnt lgkmcnt(0)
    v_cmp_gt_u32 vcc, 8, v32
    s_nop 1
    s_cbranch_vccz L_trig_47_done
    s_sleep 1
    s_sub_u32 s100, s100, 1
    s_cmp_lg_u32 s100, 0
    s_cbranch_scc1 L_trig_47
L_trig_47_done:
    s_setprio 3
L_go_46:
    buffer_load_dwordx4 v[104:107], v3, s[48:51], s68 offen nt
    s_add_u32 s68, s68, 9216
    buffer_load_dwordx4 v[108:111], v3, s[48:51], s68 offen nt
    s_add_u32 s68, s68, 9216
    buffer_load_dwordx4 v[112:115], v3, s[48:51], s68 offen nt
    s_add_u32 s68, s68, 9216
    buffer_load_dwordx4 v[116:119], v3, s[48:51], s68 offen nt
    s_add_u32 s68, s68, 9216
    buffer_load_dwordx4 v[120:123], v3, s[48:51], s68 offen nt
    s_add_u32 s68, s68, 9216
    buffer_load_dwordx4 v[124:127], v3, s[48:51], s68 offen nt
    s_add_u32 s68, s68, 9216
    buffer_load_dwordx4 v[128:131], v3, s[48:51], s68 offen nt
    s_add_u32 s68, s68, 9216
    buffer_load_dwordx4 v[132:135], v3, s[48:51], s68 offen nt
    s_add_u32 s68, s68, 9216
    buffer_load_dwordx4 v[136:139], v3, s[48:51], s68 offen nt
    s_add_u32 s68, s68, 9216
    buffer_load_dwordx4 v[140:143], v3, s[48:51], s68 offen nt
    s_add_u32 s68, s68, 9216
    buffer_load_dwordx4 v[144:147], v3, s[48:51], s68 offen nt
    s_add_u32 s68, s68, 9216
    buffer_load_dwordx4 v[148:151], v3, s[48:51], s68 offen nt
    s_add_u32 s68, s68, 9216
    buffer_load_dwordx4 v[152:155], v3, s[48:51], s68 offen nt
    s_add_u32 s68, s68, 9216
    buffer_load_dwordx4 v[156:159], v3, s[48:51], s68 offen nt
    s_add_u32 s68, s68, 9216
    buffer_load_dwordx4 v[160:163], v3, s[48:51], s68 offen nt
    s_add_u32 s68, s68, 9216
    buffer_load_dwordx4 v[164:167], v3, s[48:51], s68 offen nt
    s_cmp_lg_u32 s3, 9
    s_cbranch_scc1 L_nobar_48
    s_barrier
    s_setprio 0
L_nobar_48:
    s_waitcnt vmcnt(0)
    s_sub_u32 s73, s3, 8
    s_lshl_b32 s73, s73, 14
    s_add_u32 s73, s73, 8192
    v_lshrrev_b32 v32, 3, v45
    v_lshl_add_u32 v32, v32, 2, v46
    v_and_b32 v33, 7, v45
    v_lshlrev_b32 v33, 4, v33
    v_lshl_add_u32 v32, v32, 7, v33
    v_add_u32 v32, s73, v32
    ds_write_b128 v32, v[104:107] offset:0
    ds_write_b128 v32, v[108:111] offset:1024
    ds_write_b128 v32, v[112:115] offset:2048
    ds_write_b128 v32, v[116:119] offset:3072
    ds_write_b128 v32, v[120:123] offset:4096
    ds_write_b128 v32, v[124:127] offset:5120
    ds_write_b128 v32, v[128:131] offset:6144
    ds_write_b128 v32, v[132:135] offset:7168
    ds_write_b128 v32, v[136:139] offset:8192
    ds_write_b128 v32, v[140:143] offset:9216
    ds_write_b128 v32, v[144:147] offset:10240
    ds_write_b128 v32, v[148:151] offset:11264
    ds_write_b128 v32, v[152:155] offset:12288
    ds_write_b128 v32, v[156:159] offset:13312
    ds_write_b128 v32, v[160:163] offset:14336
    ds_write_b128 v32, v[164:167] offset:15360
    v_lshrrev_b32 v33, 2, v45
    v_lshl_add_u32 v33, v46, 3, v33
    v_and_b32 v34, 3, v45
    v_lshlrev_b32 v34, 3, v34
    v_lshl_add_u32 v33, v33, 7, v34
    v_add_u32 v33, s73, v33
    ds_read_b64_tr_b16 v[104:105], v33 offset:0
    ds_read_b64_tr_b16 v[106:107], v33 offset:512
    ds_read_b64_tr_b16 v[108:109], v33 offset:32
    ds_read_b64_tr_b16 v[110:111], v33 offset:544
    ds_read_b64_tr_b16 v[112:113], v33 offset:64
    ds_read_b64_tr_b16 v[114:115], v33 offset:576
    ds_read_b64_tr_b16 v[116:117], v33 offset:96
    ds_read_b64_tr_b16 v[118:119], v33 offset:608
    s_waitcnt lgkmcnt(0)
    ds_read_b64_tr_b16 v[120:121], v33 offset:4096
    ds_read_b64_tr_b16 v[122:123], v33 offset:4608
    ds_read_b64_tr_b16 v[124:125], v33 offset:4128
    ds_read_b64_tr_b16 v[126:127], v33 offset:4640
    ds_read_b64_tr_b16 v[128:129], v33 offset:4160
    ds_read_b64_tr_b16 v[130:131], v33 offset:4672
    ds_read_b64_tr_b16 v[132:133], v33 offset:4192
    ds_read_b64_tr_b16 v[134:135], v33 offset:4704
    s_waitcnt lgkmcnt(0)
    ds_read_b64_tr_b16 v[136:137], v33 offset:8192
    ds_read_b64_tr_b16 v[138:139], v33 offset:8704
    ds_read_b64_tr_b16 v[140:141], v33 offset:8224
    ds_read_b64_tr_b16 v[142:143], v33 offset:8736
    ds_read_b64_tr_b16 v[144:145], v33 offset:8256
    ds_read_b64_tr_b16 v[146:147], v33 offset:8768
    ds_read_b64_tr_b16 v[148:149], v33 offset:8288
    ds_read_b64_tr_b16 v[150:151], v33 offset:8800
    s_waitcnt lgkmcnt(0)
    ds_read_b64_tr_b16 v[152:153], v33 offset:12288
    ds_read_b64_tr_b16 v[154:155], v33 offset:12800
    ds_read_b64_tr_b16 v[156:157], v33 offset:12320
    ds_read_b64_tr_b16 v[158:159], v33 offset:12832
    ds_read_b64_tr_b16 v[160:161], v33 offset:12352
    ds_read_b64_tr_b16 v[162:163], v33 offset:12864
    ds_read_b64_tr_b16 v[164:165], v33 offset:12384
    ds_read_b64_tr_b16 v[166:167], v33 offset:12896
    s_waitcnt lgkmcnt(0)
    v_cvt_pk_bf16_f32 v42, v20, v21
    s_nop 1
    v_mov_b32_dpp v96, v42 row_newbcast:0 row_mask:0xf bank_mask:0xf
    v_mov_b32_dpp v97, v42 row_newbcast:1 row_mask:0xf bank_mask:0xf
    v_mov_b32_dpp v98, v42 row_newbcast:2 row_mask:0xf bank_mask:0xf
    v_mov_b32_dpp v99, v42 row_newbcast:3 row_mask:0xf bank_mask:0xf
    v_mov_b32_dpp v100, v42 row_newbcast:4 row_mask:0xf bank_mask:0xf
    v_mov_b32_dpp v101, v42 row_newbcast:5 row_mask:0xf bank_mask:0xf
    v_mov_b32_dpp v102, v42 row_newbcast:6 row_mask:0xf bank_mask:0xf
    v_mov_b32_dpp v103, v42 row_newbcast:7 row_mask:0xf bank_mask:0xf
    v_mfma_f32_16x16x32_bf16 v[24:27], v[96:99], v[104:107], 0
    v_mfma_f32_16x16x32_bf16 v[28:31], v[96:99], v[108:111], 0
    v_mfma_f32_16x16x32_bf16 v[32:35], v[96:99], v[112:115], 0
    v_mfma_f32_16x16x32_bf16 v[36:39], v[96:99], v[116:119], 0
    v_mov_b32_dpp v96, v42 row_newbcast:8 row_mask:0xf bank_mask:0xf
    v_mov_b32_dpp v97, v42 row_newbcast:9 row_mask:0xf bank_mask:0xf
    v_mov_b32_dpp v98, v42 row_newbcast:10 row_mask:0xf bank_mask:0xf
    v_mov_b32_dpp v99, v42 row_newbcast:11 row_mask:0xf bank_mask:0xf
    v_mfma_f32_16x16x32_bf16 v[24:27], v[100:103], v[120:123], v[24:27]
    v_mfma_f32_16x16x32_bf16 v[28:31], v[100:103], v[124:127], v[28:31]
    v_mfma_f32_16x16x32_bf16 v[32:35], v[100:103], v[128:131], v[32:35]
    v_mfma_f32_16x16x32_bf16 v[36:39], v[100:103], v[132:135], v[36:39]
    v_mov_b32_dpp v100, v42 row_newbcast:12 row_mask:0xf bank_mask:0xf
    v_mov_b32_dpp v101, v42 row_newbcast:13 row_mask:0xf bank_mask:0xf
    v_mov_b32_dpp v102, v42 row_newbcast:14 row_mask:0xf bank_mask:0xf
    v_mov_b32_dpp v103, v42 row_newbcast:15 row_mask:0xf bank_mask:0xf
    v_mfma_f32_16x16x32_bf16 v[24:27], v[96:99], v[136:139], v[24:27]
    v_mfma_f32_16x16x32_bf16 v[28:31], v[96:99], v[140:143], v[28:31]
    v_mfma_f32_16x16x32_bf16 v[32:35], v[96:99], v[144:147], v[32:35]
    v_mfma_f32_16x16x32_bf16 v[36:39], v[96:99], v[148:151], v[36:39]
    v_mfma_f32_16x16x32_bf16 v[24:27], v[100:103], v[152:155], v[24:27]
    v_mfma_f32_16x16x32_bf16 v[28:31], v[100:103], v[156:159], v[28:31]
    v_mfma_f32_16x16x32_bf16 v[32:35], v[100:103], v[160:163], v[32:35]
    v_mfma_f32_16x16x32_bf16 v[36:39], v[100:103], v[164:167], v[36:39]
    s_nop 4
    v_add_u32 v20, 0x800, v24
    v_add_u32 v21, 0x800, v28
    v_add_u32 v22, 0x800, v32
    v_add_u32 v23, 0x800, v36
    v_bfi_b32 v20, s76, v12, v20
    v_bfi_b32 v21, s76, v13, v21
    v_bfi_b32 v22, s76, v14, v22
    v_bfi_b32 v23, s76, v15, v23
    s_mov_b32 exec_lo, 0xffff
    s_mov_b32 exec_hi, 0x0
    buffer_store_dwordx4 v[20:23], v1, s[60:63], s70 offen sc1
    s_mov_b64 exec, -1
    s_nop 1
    s_setpc_b64 s[58:59]
L_att:
    s_lshl_b32 s70, s66, 3
    s_add_u32 s70, s70, s67
    s_lshl_b32 s70, s70, 18
    s_mul_i32 s73, s3, 1024
    s_add_u32 s70, s70, s73
    s_mov_b32 s71, s70
    s_waitcnt lgkmcnt(0)
    s_mov_b32 s32, s6
    s_mov_b32 s33, s7
    s_mov_b32 s34, 67108864
    s_mov_b32 s35, 0x20000
    s_barrier
    buffer_load_dwordx4 v[48:51], v1, s[32:35], s70 offen nt
    s_add_u32 s70, s70, 8192
    buffer_load_dwordx4 v[52:55], v1, s[32:35], s70 offen nt
    s_add_u32 s70, s70, 8192
    s_load_dword s14, s[26:27], 0
    s_load_dword s15, s[26:27], 1040384
    s_mov_b32 s36, s8
    s_mov_b32 s37, s9
    s_mov_b32 s38, 67108864
    s_mov_b32 s39, 0x20000
    s_mov_b32 s60, s26
    s_mov_b32 s61, s27
    s_mov_b32 s62, 268435456
    s_mov_b32 s63, 0x20000
    s_mov_b32 s76, 0xcccccccc
    s_mov_b32 s77, 0xcccccccc
    s_mov_b32 s78, 0xaaaaaaaa
    s_mov_b32 s79, 0xaaaaaaaa
    v_and_b32 v32, 1, v45
    v_lshlrev_b32 v32, 4, v32
    v_mov_b32 v33, 0xffff
    v_lshlrev_b32 v33, v32, v33
    v_lshrrev_b32 v32, 1, v45
    v_cmp_eq_u32 vcc, 0, v32
    s_nop 1
    v_cndmask_b32 v4, 0, v33, vcc
    v_cmp_eq_u32 vcc, 1, v32
    s_nop 1
    v_cndmask_b32 v5, 0, v33, vcc
    v_cmp_eq_u32 vcc, 2, v32
    s_nop 1
    v_cndmask_b32 v6, 0, v33, vcc
    v_cmp_eq_u32 vcc, 3, v32
    s_nop 1
    v_cndmask_b32 v7, 0, v33, vcc
    v_lshlrev_b32 v44, 4, v45
    v_mov_b32 v47, 0
    s_waitcnt vmcnt(1)
    buffer_load_dwordx4 v[56:59], v1, s[32:35], s70 offen nt
    s_add_u32 s70, s70, 8192
    s_waitcnt vmcnt(1)
    buffer_load_dwordx4 v[60:63], v1, s[32:35], s70 offen nt
    s_add_u32 s70, s70, 8192
    s_waitcnt vmcnt(1)
    buffer_load_dwordx4 v[64:67], v1, s[32:35], s70 offen nt
    s_add_u32 s70, s70, 8192
    s_waitcnt vmcnt(1)
    buffer_load_dwordx4 v[68:71], v1, s[32:35], s70 offen nt
    s_add_u32 s70, s70, 8192
    s_waitcnt vmcnt(1)
    buffer_load_dwordx4 v[72:75], v1, s[32:35], s70 offen nt
    s_add_u32 s70, s70, 8192
    s_waitcnt vmcnt(1)
    buffer_load_dwordx4 v[76:79], v1, s[32:35], s70 offen nt
    s_add_u32 s70, s70, 8192
    s_waitcnt vmcnt(1)
    buffer_load_dwordx4 v[80:83], v1, s[32:35], s70 offen nt
    s_add_u32 s70, s70, 8192
    s_mov_b32 s100, 0x800000
L_q_49:
    ds_read_b32 v32, v47 offset:1608
    ds_read_b128 v[12:15], v44 offset:0
    s_waitcnt lgkmcnt(0)
    v_cmp_eq_u32 vcc, 0, v32
    s_nop 1
    s_cbranch_vccz L_q_49_done
    s_sleep 1
    s_sub_u32 s100, s100, 1
    s_cmp_lg_u32 s100, 0
    s_cbranch_scc1 L_q_49
L_q_49_done:
    buffer_load_dwordx4 v[84:87], v1, s[32:35], s70 offen nt
    s_add_u32 s70, s70, 8192
    buffer_load_dwordx4 v[88:91], v1, s[32:35], s70 offen nt
    s_add_u32 s70, s70, 8192
    buffer_load_dwordx4 v[92:95], v1, s[32:35], s70 offen nt
    s_add_u32 s70, s70, 8192
    s_add_u32 s14, s14, 1
    s_cmp_eq_u32 s14, s15
    s_addc_u32 s14, s14, 0
    s_not_b32 s15, s14
    s_bitcmp0_b32 s2, 0
    s_cselect_b64 vcc, -1, 0
    s_cbranch_vccz L_nb_50
    s_waitcnt vmcnt(4)
L_nb_50:
    v_dot2_f32_bf16 v32, v48, v12, 0
    v_dot2_f32_bf16 v32, v49, v13, v32
    v_dot2_f32_bf16 v32, v50, v14, v32
    v_dot2_f32_bf16 v32, v51, v15, v32
    s_cbranch_vccz L_nb_51
    s_waitcnt vmcnt(4)
L_nb_51:
    v_dot2_f32_bf16 v33, v52, v12, 0
    v_dot2_f32_bf16 v33, v53, v13, v33
    v_dot2_f32_bf16 v33, v54, v14, v33
    v_dot2_f32_bf16 v33, v55, v15, v33
    v_add_f32_dpp v32, v32, v32 row_ror:8 row_mask:0xf bank_mask:0x3
    s_nop 1
    v_add_f32_dpp v32, v33, v33 row_ror:8 row_mask:0xf bank_mask:0xc
    s_cbranch_vccz L_nb_52
    s_waitcnt vmcnt(4)
L_nb_52:
    v_dot2_f32_bf16 v34, v56, v12, 0
    v_dot2_f32_bf16 v34, v57, v13, v34
    v_dot2_f32_bf16 v34, v58, v14, v34
    v_dot2_f32_bf16 v34, v59, v15, v34
    s_cbranch_vccz L_nb_53
    s_waitcnt vmcnt(4)
L_nb_53:
    v_dot2_f32_bf16 v35, v60, v12, 0
    v_dot2_f32_bf16 v35, v61, v13, v35
    v_dot2_f32_bf16 v35, v62, v14, v35
    v_dot2_f32_bf16 v35, v63, v15, v35
    v_add_f32_dpp v34, v34, v34 row_ror:8 row_mask:0xf bank_mask:0x3
    s_nop 1
    v_add_f32_dpp v34, v35, v35 row_ror:8 row_mask:0xf bank_mask:0xc
    v_add_f32_dpp v32, v32, v32 row_half_mirror row_mask:0xf bank_mask:0x5
    s_nop 1
    v_add_f32_dpp v32, v34, v34 row_half_mirror row_mask:0xf bank_mask:0xa
    s_cbranch_vccz L_nb_54
    s_waitcnt vmcnt(4)
L_nb_54:
    v_dot2_f32_bf16 v36, v64, v12, 0
    v_dot2_f32_bf16 v36, v65, v13, v36
    v_dot2_f32_bf16 v36, v66, v14, v36
    v_dot2_f32_bf16 v36, v67, v15, v36
    s_cbranch_vccz L_nb_55
    s_waitcnt vmcnt(4)
L_nb_55:
    v_dot2_f32_bf16 v37, v68, v12, 0
    v_dot2_f32_bf16 v37, v69, v13, v37
    v_dot2_f32_bf16 v37, v70, v14, v37
    v_dot2_f32_bf16 v37, v71, v15, v37
    v_add_f32_dpp v36, v36, v36 row_ror:8 row_mask:0xf bank_mask:0x3
    s_nop 1
    v_add_f32_dpp v36, v37, v37 row_ror:8 row_mask:0xf bank_mask:0xc
    s_cbranch_vccz L_nb_56
    s_waitcnt vmcnt(4)
L_nb_56:
    v_dot2_f32_bf16 v38, v72, v12, 0
    v_dot2_f32_bf16 v38, v73, v13, v38
    v_dot2_f32_bf16 v38, v74, v14, v38
    v_dot2_f32_bf16 v38, v75, v15, v38
    s_waitcnt vmcnt(4)
    s_cbranch_vccz L_nb_57
    s_waitcnt vmcnt(3)
L_nb_57:
    v_dot2_f32_bf16 v39, v76, v12, 0
    v_dot2_f32_bf16 v39, v77, v13, v39
    v_dot2_f32_bf16 v39, v78, v14, v39
    v_dot2_f32_bf16 v39, v79, v15, v39
    v_add_f32_dpp v38, v38, v38 row_ror:8 row_mask:0xf bank_mask:0x3
    s_nop 1
    v_add_f32_dpp v38, v39, v39 row_ror:8 row_mask:0xf bank_mask:0xc
    v_add_f32_dpp v36, v36, v36 row_half_mirror row_mask:0xf bank_mask:0x5
    s_nop 1
    v_add_f32_dpp v36, v38, v38 row_half_mirror row_mask:0xf bank_mask:0xa
    v_add_f32_dpp v32, v32, v32 quad_perm:[2,3,0,1] row_mask:0xf bank_mask:0xf
    s_nop 0
    v_add_f32_dpp v36, v36, v36 quad_perm:[2,3,0,1] row_mask:0xf bank_mask:0xf
    v_cndmask_b32 v32, v32, v36, s[76:77]
    s_waitcnt vmcnt(3)
    s_cbranch_vccz L_nb_58
    s_waitcnt vmcnt(2)
L_nb_58:
    buffer_load_dwordx4 v[48:51], v1, s[32:35], s70 offen nt
    s_add_u32 s70, s70, 8192
    v_dot2_f32_bf16 v33, v80, v12, 0
    v_dot2_f32_bf16 v33, v81, v13, v33
    v_dot2_f32_bf16 v33, v82, v14, v33
    v_dot2_f32_bf16 v33, v83, v15, v33
    s_waitcnt vmcnt(3)
    s_cbranch_vccz L_nb_59
    s_waitcnt vmcnt(2)
L_nb_59:
    buffer_load_dwordx4 v[52:55], v1, s[32:35], s70 offen nt
    s_add_u32 s70, s70, 8192
    v_dot2_f32_bf16 v35, v84, v12, 0
    v_dot2_f32_bf16 v35, v85, v13, v35
    v_dot2_f32_bf16 v35, v86, v14, v35
    v_dot2_f32_bf16 v35, v87, v15, v35
    v_add_f32_dpp v33, v33, v33 row_ror:8 row_mask:0xf bank_mask:0x3
    s_nop 1
    v_add_f32_dpp v33, v35, v35 row_ror:8 row_mask:0xf bank_mask:0xc
    s_waitcnt vmcnt(3)
    s_cbranch_vccz L_nb_60
    s_waitcnt vmcnt(2)
L_nb_60:
    buffer_load_dwordx4 v[56:59], v1, s[32:35], s70 offen nt
    s_add_u32 s70, s70, 8192
    v_dot2_f32_bf16 v34, v88, v12, 0
    v_dot2_f32_bf16 v34, v89, v13, v34
    v_dot2_f32_bf16 v34, v90, v14, v34
    v_dot2_f32_bf16 v34, v91, v15, v34
    s_waitcnt vmcnt(3)
    s_cbranch_vccz L_nb_61
    s_waitcnt vmcnt(2)
L_nb_61:
    buffer_load_dwordx4 v[60:63], v1, s[32:35], s70 offen nt
    s_add_u32 s70, s70, 8192
    v_dot2_f32_bf16 v37, v92, v12, 0
    v_dot2_f32_bf16 v37, v93, v13, v37
    v_dot2_f32_bf16 v37, v94, v14, v37
    v_dot2_f32_bf16 v37, v95, v15, v37
    v_add_f32_dpp v34, v34, v34 row_ror:8 row_mask:0xf bank_mask:0x3
    s_nop 1
    v_add_f32_dpp v34, v37, v37 row_ror:8 row_mask:0xf bank_mask:0xc
    v_add_f32_dpp v33, v33, v33 row_half_mirror row_mask:0xf bank_mask:0x5
    s_nop 1
    v_add_f32_dpp v33, v34, v34 row_half_mirror row_mask:0xf bank_mask:0xa
    s_waitcnt vmcnt(3)
    s_cbranch_vccz L_nb_62
    s_waitcnt vmcnt(2)
L_nb_62:
    buffer_load_dwordx4 v[64:67], v1, s[32:35], s70 offen nt
    s_add_u32 s70, s70, 8192
    v_dot2_f32_bf16 v39, v48, v12, 0
    v_dot2_f32_bf16 v39, v49, v13, v39
    v_dot2_f32_bf16 v39, v50, v14, v39
    v_dot2_f32_bf16 v39, v51, v15, v39
    s_waitcnt vmcnt(3)
    s_cbranch_vccz L_nb_63
    s_waitcnt vmcnt(2)
L_nb_63:
    buffer_load_dwordx4 v[48:51], v1, s[32:35], s70 offen nt
    s_add_u32 s70, s70, 8192
    v_dot2_f32_bf16 v38, v52, v12, 0
    v_dot2_f32_bf16 v38, v53, v13, v38
    v_dot2_f32_bf16 v38, v54, v14, v38
    v_dot2_f32_bf16 v38, v55, v15, v38
    v_add_f32_dpp v39, v39, v39 row_ror:8 row_mask:0xf bank_mask:0x3
    s_nop 1
    v_add_f32_dpp v39, v38, v38 row_ror:8 row_mask:0xf bank_mask:0xc
    s_waitcnt vmcnt(3)
    s_cbranch_vccz L_nb_64
    s_waitcnt vmcnt(2)
L_nb_64:
    buffer_load_dwordx4 v[52:55], v1, s[32:35], s70 offen nt
    s_add_u32 s70, s70, 8192
    v_dot2_f32_bf16 v36, v56, v12, 0
    v_dot2_f32_bf16 v36, v57, v13, v36
    v_dot2_f32_bf16 v36, v58, v14, v36
    v_dot2_f32_bf16 v36, v59, v15, v36
    s_waitcnt vmcnt(3)
    s_cbranch_vccz L_nb_65
    s_waitcnt vmcnt(2)
L_nb_65:
    buffer_load_dwordx4 v[56:59], v1, s[32:35], s70 offen nt
    s_add_u32 s70, s70, 8192
    v_dot2_f32_bf16 v35, v60, v12, 0
    v_dot2_f32_bf16 v35, v61, v13, v35
    v_dot2_f32_bf16 v35, v62, v14, v35
    v_dot2_f32_bf16 v35, v63, v15, v35
    v_add_f32_dpp v36, v36, v36 row_ror:8 row_mask:0xf bank_mask:0x3
    s_nop 1
    v_add_f32_dpp v36, v35, v35 row_ror:8 row_mask:0xf bank_mask:0xc
    v_add_f32_dpp v39, v39, v39 row_half_mirror row_mask:0xf bank_mask:0x5
    s_nop 1
    v_add_f32_dpp v39, v36, v36 row_half_mirror row_mask:0xf bank_mask:0xa
    v_add_f32_dpp v33, v33, v33 quad_perm:[2,3,0,1] row_mask:0xf bank_mask:0xf
    s_nop 0
    v_add_f32_dpp v39, v39, v39 quad_perm:[2,3,0,1] row_mask:0xf bank_mask:0xf
    v_cndmask_b32 v33, v33, v39, s[76:77]
    v_add_f32_dpp v32, v32, v32 quad_perm:[1,0,3,2] row_mask:0xf bank_mask:0xf
    s_nop 0
    v_add_f32_dpp v33, v33, v33 quad_perm:[1,0,3,2] row_mask:0xf bank_mask:0xf
    v_cndmask_b32 v40, v32, v33, s[78:79]
    s_waitcnt vmcnt(3)
    s_cbranch_vccz L_nb_66
    s_waitcnt vmcnt(2)
L_nb_66:
    buffer_load_dwordx4 v[60:63], v1, s[32:35], s70 offen nt
    s_add_u32 s70, s70, 8192
    v_dot2_f32_bf16 v37, v64, v12, 0
    v_dot2_f32_bf16 v37, v65, v13, v37
    v_dot2_f32_bf16 v37, v66, v14, v37
    v_dot2_f32_bf16 v37, v67, v15, v37
    s_waitcnt vmcnt(3)
    s_cbranch_vccz L_nb_67
    s_waitcnt vmcnt(2)
L_nb_67:
    buffer_load_dwordx4 v[64:67], v1, s[32:35], s70 offen nt
    s_add_u32 s70, s70, 8192
    v_dot2_f32_bf16 v34, v48, v12, 0
    v_dot2_f32_bf16 v34, v49, v13, v34
    v_dot2_f32_bf16 v34, v50, v14, v34
    v_dot2_f32_bf16 v34, v51, v15, v34
    v_add_f32_dpp v37, v37, v37 row_ror:8 row_mask:0xf bank_mask:0x3
    s_nop 1
    v_add_f32_dpp v37, v34, v34 row_ror:8 row_mask:0xf bank_mask:0xc
    s_waitcnt vmcnt(3)
    s_cbranch_vccz L_nb_68
    s_waitcnt vmcnt(2)
L_nb_68:
    buffer_load_dwordx4 v[48:51], v1, s[32:35], s70 offen nt
    s_add_u32 s70, s70, 8192
    v_dot2_f32_bf16 v38, v52, v12, 0
    v_dot2_f32_bf16 v38, v53, v13, v38
    v_dot2_f32_bf16 v38, v54, v14, v38
    v_dot2_f32_bf16 v38, v55, v15, v38
    s_waitcnt vmcnt(3)
    s_cbranch_vccz L_nb_69
    s_waitcnt vmcnt(2)
L_nb_69:
    buffer_load_dwordx4 v[52:55], v1, s[32:35], s70 offen nt
    s_add_u32 s70, s70, 8192
    v_dot2_f32_bf16 v35, v56, v12, 0
    v_dot2_f32_bf16 v35, v57, v13, v35
    v_dot2_f32_bf16 v35, v58, v14, v35
    v_dot2_f32_bf16 v35, v59, v15, v35
    v_add_f32_dpp v38, v38, v38 row_ror:8 row_mask:0xf bank_mask:0x3
    s_nop 1
    v_add_f32_dpp v38, v35, v35 row_ror:8 row_mask:0xf bank_mask:0xc
    v_add_f32_dpp v37, v37, v37 row_half_mirror row_mask:0xf bank_mask:0x5
    s_nop 1
    v_add_f32_dpp v37, v38, v38 row_half_mirror row_mask:0xf bank_mask:0xa
    s_waitcnt vmcnt(3)
    s_cbranch_vccz L_nb_70
    s_waitcnt vmcnt(2)
L_nb_70:
    buffer_load_dwordx4 v[56:59], v1, s[32:35], s70 offen nt
    s_add_u32 s70, s70, 8192
    v_dot2_f32_bf16 v36, v60, v12, 0
    v_dot2_f32_bf16 v36, v61, v13, v36
    v_dot2_f32_bf16 v36, v62, v14, v36
    v_dot2_f32_bf16 v36, v63, v15, v36
    s_waitcnt vmcnt(3)
    s_cbranch_vccz L_nb_71
    s_waitcnt vmcnt(2)
L_nb_71:
    buffer_load_dwordx4 v[60:63], v1, s[32:35], s70 offen nt
    s_add_u32 s70, s70, 8192
    v_dot2_f32_bf16 v39, v64, v12, 0
    v_dot2_f32_bf16 v39, v65, v13, v39
    v_dot2_f32_bf16 v39, v66, v14, v39
    v_dot2_f32_bf16 v39, v67, v15, v39
    v_add_f32_dpp v36, v36, v36 row_ror:8 row_mask:0xf bank_mask:0x3
    s_nop 1
    v_add_f32_dpp v36, v39, v39 row_ror:8 row_mask:0xf bank_mask:0xc
    s_waitcnt vmcnt(3)
    s_cbranch_vccz L_nb_72
    s_waitcnt vmcnt(2)
L_nb_72:
    buffer_load_dwordx4 v[64:67], v1, s[32:35], s70 offen nt
    s_add_u32 s70, s70, 8192
    v_dot2_f32_bf16 v32, v48, v12, 0
    v_dot2_f32_bf16 v32, v49, v13, v32
    v_dot2_f32_bf16 v32, v50, v14, v32
    v_dot2_f32_bf16 v32, v51, v15, v32
    s_waitcnt vmcnt(3)
    s_cbranch_vccz L_nb_73
    s_waitcnt vmcnt(2)
L_nb_73:
    buffer_load_dwordx4 v[48:51], v1, s[32:35], s70 offen nt
    s_add_u32 s70, s70, 8192
    v_dot2_f32_bf16 v33, v52, v12, 0
    v_dot2_f32_bf16 v33, v53, v13, v33
    v_dot2_f32_bf16 v33, v54, v14, v33
    v_dot2_f32_bf16 v33, v55, v15, v33
    v_add_f32_dpp v32, v32, v32 row_ror:8 row_mask:0xf bank_mask:0x3
    s_nop 1
    v_add_f32_dpp v32, v33, v33 row_ror:8 row_mask:0xf bank_mask:0xc
    v_add_f32_dpp v36, v36, v36 row_half_mirror row_mask:0xf bank_mask:0x5
    s_nop 1
    v_add_f32_dpp v36, v32, v32 row_half_mirror row_mask:0xf bank_mask:0xa
    v_add_f32_dpp v37, v37, v37 quad_perm:[2,3,0,1] row_mask:0xf bank_mask:0xf
    s_nop 0
    v_add_f32_dpp v36, v36, v36 quad_perm:[2,3,0,1] row_mask:0xf bank_mask:0xf
    v_cndmask_b32 v37, v37, v36, s[76:77]
    s_waitcnt vmcnt(3)
    s_cbranch_vccz L_nb_74
    s_waitcnt vmcnt(2)
L_nb_74:
    buffer_load_dwordx4 v[52:55], v1, s[32:35], s70 offen nt
    s_add_u32 s70, s70, 8192
    v_dot2_f32_bf16 v34, v56, v12, 0
    v_dot2_f32_bf16 v34, v57, v13, v34
    v_dot2_f32_bf16 v34, v58, v14, v34
    v_dot2_f32_bf16 v34, v59, v15, v34
    s_waitcnt vmcnt(3)
    s_cbranch_vccz L_nb_75
    s_waitcnt vmcnt(2)
L_nb_75:
    buffer_load_dwordx4 v[56:59], v1, s[32:35], s70 offen nt
    s_add_u32 s70, s70, 8192
    v_dot2_f32_bf16 v35, v60, v12, 0
    v_dot2_f32_bf16 v35, v61, v13, v35
    v_dot2_f32_bf16 v35, v62, v14, v35
    v_dot2_f32_bf16 v35, v63, v15, v35
    v_add_f32_dpp v34, v34, v34 row_ror:8 row_mask:0xf bank_mask:0x3
    s_nop 1
    v_add_f32_dpp v34, v35, v35 row_ror:8 row_mask:0xf bank_mask:0xc
    s_waitcnt vmcnt(3)
    s_cbranch_vccz L_nb_76
    s_waitcnt vmcnt(2)
L_nb_76:
    buffer_load_dwordx4 v[60:63], v1, s[32:35], s70 offen nt
    s_add_u32 s70, s70, 8192
    v_dot2_f32_bf16 v38, v64, v12, 0
    v_dot2_f32_bf16 v38, v65, v13, v38
    v_dot2_f32_bf16 v38, v66, v14, v38
    v_dot2_f32_bf16 v38, v67, v15, v38
    s_waitcnt vmcnt(3)
    s_cbranch_vccz L_nb_77
    s_waitcnt vmcnt(2)
L_nb_77:
    buffer_load_dwordx4 v[64:67], v1, s[32:35], s70 offen nt
    s_add_u32 s70, s70, 8192
    v_dot2_f32_bf16 v39, v48, v12, 0
    v_dot2_f32_bf16 v39, v49, v13, v39
    v_dot2_f32_bf16 v39, v50, v14, v39
    v_dot2_f32_bf16 v39, v51, v15, v39
    v_add_f32_dpp v38, v38, v38 row_ror:8 row_mask:0xf bank_mask:0x3
    s_nop 1
    v_add_f32_dpp v38, v39, v39 row_ror:8 row_mask:0xf bank_mask:0xc
    v_add_f32_dpp v34, v34, v34 row_half_mirror row_mask:0xf bank_mask:0x5
    s_nop 1
    v_add_f32_dpp v34, v38, v38 row_half_mirror row_mask:0xf bank_mask:0xa
    s_waitcnt vmcnt(3)
    s_cbranch_vccz L_nb_78
    s_waitcnt vmcnt(2)
L_nb_78:
    buffer_load_dwordx4 v[48:51], v1, s[36:39], s71 offen nt
    s_add_u32 s71, s71, 8192
    v_dot2_f32_bf16 v33, v52, v12, 0
    v_dot2_f32_bf16 v33, v53, v13, v33
    v_dot2_f32_bf16 v33, v54, v14, v33
    v_dot2_f32_bf16 v33, v55, v15, v33
    s_waitcnt vmcnt(3)
    s_cbranch_vccz L_nb_79
    s_waitcnt vmcnt(2)
L_nb_79:
    buffer_load_dwordx4 v[52:55], v1, s[36:39], s71 offen nt
    s_add_u32 s71, s71, 8192
    v_dot2_f32_bf16 v32, v56, v12, 0
    v_dot2_f32_bf16 v32, v57, v13, v32
    v_dot2_f32_bf16 v32, v58, v14, v32
    v_dot2_f32_bf16 v32, v59, v15, v32
    v_add_f32_dpp v33, v33, v33 row_ror:8 row_mask:0xf bank_mask:0x3
    s_nop 1
    v_add_f32_dpp v33, v32, v32 row_ror:8 row_mask:0xf bank_mask:0xc
    s_waitcnt vmcnt(3)
    s_cbranch_vccz L_nb_80
    s_waitcnt vmcnt(2)
L_nb_80:
    buffer_load_dwordx4 v[56:59], v1, s[36:39], s71 offen nt
    s_add_u32 s71, s71, 8192
    v_dot2_f32_bf16 v36, v60, v12, 0
    v_dot2_f32_bf16 v36, v61, v13, v36
    v_dot2_f32_bf16 v36, v62, v14, v36
    v_dot2_f32_bf16 v36, v63, v15, v36
    s_waitcnt vmcnt(3)
    s_cbranch_vccz L_nb_81
    s_waitcnt vmcnt(2)
L_nb_81:
    buffer_load_dwordx4 v[60:63], v1, s[36:39], s71 offen nt
    s_add_u32 s71, s71, 8192
    v_dot2_f32_bf16 v35, v64, v12, 0
    v_dot2_f32_bf16 v35, v65, v13, v35
    v_dot2_f32_bf16 v35, v66, v14, v35
    v_dot2_f32_bf16 v35, v67, v15, v35
    v_add_f32_dpp v36, v36, v36 row_ror:8 row_mask:0xf bank_mask:0x3
    s_nop 1
    v_add_f32_dpp v36, v35, v35 row_ror:8 row_mask:0xf bank_mask:0xc
    v_add_f32_dpp v33, v33, v33 row_half_mirror row_mask:0xf bank_mask:0x5
    s_nop 1
    v_add_f32_dpp v33, v36, v36 row_half_mirror row_mask:0xf bank_mask:0xa
    v_add_f32_dpp v34, v34, v34 quad_perm:[2,3,0,1] row_mask:0xf bank_mask:0xf
    s_nop 0
    v_add_f32_dpp v33, v33, v33 quad_perm:[2,3,0,1] row_mask:0xf bank_mask:0xf
    v_cndmask_b32 v34, v34, v33, s[76:77]
    v_add_f32_dpp v37, v37, v37 quad_perm:[1,0,3,2] row_mask:0xf bank_mask:0xf
    s_nop 0
    v_add_f32_dpp v34, v34, v34 quad_perm:[1,0,3,2] row_mask:0xf bank_mask:0xf
    v_cndmask_b32 v41, v37, v34, s[78:79]
    v_cvt_pk_bf16_f32 v32, v40, v41
    v_lshlrev_b32 v40, 16, v32
    v_and_b32 v41, 0xffff0000, v32
    v_mul_f32 v40, 0x3db504f3, v40
    v_mul_f32 v41, 0x3db504f3, v41
    v_cvt_pk_bf16_f32 v32, v40, v41
    v_lshlrev_b32 v40, 16, v32
    v_and_b32 v41, 0xffff0000, v32
    v_max_f32 v34, v40, v41
    s_nop 1
    v_max_f32_dpp v34, v34, v34 row_ror:8 row_mask:0xf bank_mask:0xf
    s_nop 1
    v_max_f32_dpp v34, v34, v34 row_half_mirror row_mask:0xf bank_mask:0xf
    s_nop 1
    v_max_f32_dpp v34, v34, v34 quad_perm:[2,3,0,1] row_mask:0xf bank_mask:0xf
    s_nop 1
    v_max_f32_dpp v34, v34, v34 quad_perm:[1,0,3,2] row_mask:0xf bank_mask:0xf
    v_mov_b32 v32, v34
    s_nop 1
    v_permlane16_swap_b32 v34, v32
    v_max_f32 v34, v34, v32
    v_mov_b32 v32, v34
    s_nop 1
    v_permlane32_swap_b32 v34, v32
    v_max_f32 v34, v34, v32
    v_sub_f32 v40, v40, v34
    v_sub_f32 v41, v41, v34
    v_mul_f32 v40, 0x3fb8aa3b, v40
    v_mul_f32 v41, 0x3fb8aa3b, v41
    v_exp_f32 v40, v40
    v_exp_f32 v41, v41
    s_nop 0
    v_add_f32 v35, v40, v41
    v_cvt_pk_bf16_f32 v42, v40, v40
    v_cvt_pk_bf16_f32 v43, v41, v41
    v_add_f32_dpp v35, v35, v35 row_ror:8 row_mask:0xf bank_mask:0xf
    s_nop 1
    v_add_f32_dpp v35, v35, v35 row_half_mirror row_mask:0xf bank_mask:0xf
    s_nop 1
    v_add_f32_dpp v35, v35, v35 quad_perm:[2,3,0,1] row_mask:0xf bank_mask:0xf
    s_nop 1
    v_add_f32_dpp v35, v35, v35 quad_perm:[1,0,3,2] row_mask:0xf bank_mask:0xf
    v_mov_b32 v32, v35
    s_nop 1
    v_permlane16_swap_b32 v35, v32
    v_add_f32 v35, v35, v32
    v_mov_b32 v32, v35
    s_nop 1
    v_permlane32_swap_b32 v35, v32
    v_add_f32 v35, v35, v32
    s_lshl_b32 s72, s3, 3
    v_mov_b32 v44, s72
    v_mov_b32 v32, 0
    v_mov_b32 v33, 1
    s_mov_b64 exec, 1
    ds_write_b64 v44, v[34:35] offset:1536
    ds_add_u32 v32, v33 offset:1600
    s_mov_b64 exec, -1
    v_and_b32 v44, 7, v0
    v_lshlrev_b32 v44, 4, v44
    v_mov_b32 v40, v34
    s_lshl_b32 s68, s66, 8
    s_add_u32 s68, s68, 1028096
    v_and_b32_dpp v24, v42, v4 row_newbcast:0 row_mask:0xf bank_mask:0xf
    v_and_b32_dpp v25, v42, v5 row_newbcast:0 row_mask:0xf bank_mask:0xf
    v_and_b32_dpp v26, v42, v6 row_newbcast:0 row_mask:0xf bank_mask:0xf
    v_and_b32_dpp v27, v42, v7 row_newbcast:0 row_mask:0xf bank_mask:0xf
    v_and_b32_dpp v28, v42, v4 row_newbcast:8 row_mask:0xf bank_mask:0xf
    v_and_b32_dpp v29, v42, v5 row_newbcast:8 row_mask:0xf bank_mask:0xf
    v_and_b32_dpp v30, v42, v6 row_newbcast:8 row_mask:0xf bank_mask:0xf
    v_and_b32_dpp v31, v42, v7 row_newbcast:8 row_mask:0xf bank_mask:0xf
    s_waitcnt vmcnt(3)
    s_cbranch_vccz L_nb_82
    s_waitcnt vmcnt(2)
L_nb_82:
    buffer_load_dwordx4 v[64:67], v1, s[36:39], s71 offen nt
    s_add_u32 s71, s71, 8192
    v_mfma_f32_16x16x32_bf16 v[16:19], v[24:27], v[48:51], 0
    v_and_b32_dpp v24, v42, v4 row_newbcast:4 row_mask:0xf bank_mask:0xf
    v_and_b32_dpp v25, v42, v5 row_newbcast:4 row_mask:0xf bank_mask:0xf
    v_and_b32_dpp v26, v42, v6 row_newbcast:4 row_mask:0xf bank_mask:0xf
    v_and_b32_dpp v27, v42, v7 row_newbcast:4 row_mask:0xf bank_mask:0xf
    s_waitcnt vmcnt(3)
    s_cbranch_vccz L_nb_83
    s_waitcnt vmcnt(2)
L_nb_83:
    buffer_load_dwordx4 v[48:51], v1, s[36:39], s71 offen nt
    s_add_u32 s71, s71, 8192
    v_mfma_f32_16x16x32_bf16 v[16:19], v[28:31], v[52:55], v[16:19]
    v_and_b32_dpp v28, v42, v4 row_newbcast:12 row_mask:0xf bank_mask:0xf
    v_and_b32_dpp v29, v42, v5 row_newbcast:12 row_mask:0xf bank_mask:0xf
    v_and_b32_dpp v30, v42, v6 row_newbcast:12 row_mask:0xf bank_mask:0xf
    v_and_b32_dpp v31, v42, v7 row_newbcast:12 row_mask:0xf bank_mask:0xf
    s_waitcnt vmcnt(3)
    s_cbranch_vccz L_nb_84
    s_waitcnt vmcnt(2)
L_nb_84:
    buffer_load_dwordx4 v[52:55], v1, s[36:39], s71 offen nt
    s_add_u32 s71, s71, 8192
    v_mfma_f32_16x16x32_bf16 v[16:19], v[24:27], v[56:59], v[16:19]
    v_and_b32_dpp v24, v42, v4 row_newbcast:2 row_mask:0xf bank_mask:0xf
    v_and_b32_dpp v25, v42, v5 row_newbcast:2 row_mask:0xf bank_mask:0xf
    v_and_b32_dpp v26, v42, v6 row_newbcast:2 row_mask:0xf bank_mask:0xf
    v_and_b32_dpp v27, v42, v7 row_newbcast:2 row_mask:0xf bank_mask:0xf
    s_waitcnt vmcnt(3)
    s_cbranch_vccz L_nb_85
    s_waitcnt vmcnt(2)
L_nb_85:
    buffer_load_dwordx4 v[56:59], v1, s[36:39], s71 offen nt
    s_add_u32 s71, s71, 8192
    v_mfma_f32_16x16x32_bf16 v[16:19], v[28:31], v[60:63], v[16:19]
    v_and_b32_dpp v28, v42, v4 row_newbcast:10 row_mask:0xf bank_mask:0xf
    v_and_b32_dpp v29, v42, v5 row_newbcast:10 row_mask:0xf bank_mask:0xf
    v_and_b32_dpp v30, v42, v6 row_newbcast:10 row_mask:0xf bank_mask:0xf
    v_and_b32_dpp v31, v42, v7 row_newbcast:10 row_mask:0xf bank_mask:0xf
    s_waitcnt vmcnt(3)
    s_cbranch_vccz L_nb_86
    s_waitcnt vmcnt(2)
L_nb_86:
    buffer_load_dwordx4 v[60:63], v1, s[36:39], s71 offen nt
    s_add_u32 s71, s71, 8192
    v_mfma_f32_16x16x32_bf16 v[16:19], v[24:27], v[64:67], v[16:19]
    v_and_b32_dpp v24, v42, v4 row_newbcast:6 row_mask:0xf bank_mask:0xf
    v_and_b32_dpp v25, v42, v5 row_newbcast:6 row_mask:0xf bank_mask:0xf
    v_and_b32_dpp v26, v42, v6 row_newbcast:6 row_mask:0xf bank_mask:0xf
    v_and_b32_dpp v27, v42, v7 row_newbcast:6 row_mask:0xf bank_mask:0xf
    s_waitcnt vmcnt(3)
    s_cbranch_vccz L_nb_87
    s_waitcnt vmcnt(2)
L_nb_87:
    buffer_load_dwordx4 v[64:67], v1, s[36:39], s71 offen nt
    s_add_u32 s71, s71, 8192
    v_mfma_f32_16x16x32_bf16 v[16:19], v[28:31], v[48:51], v[16:19]
    v_and_b32_dpp v28, v42, v4 row_newbcast:14 row_mask:0xf bank_mask:0xf
    v_and_b32_dpp v29, v42, v5 row_newbcast:14 row_mask:0xf bank_mask:0xf
    v_and_b32_dpp v30, v42, v6 row_newbcast:14 row_mask:0xf bank_mask:0xf
    v_and_b32_dpp v31, v42, v7 row_newbcast:14 row_mask:0xf bank_mask:0xf
    s_waitcnt vmcnt(3)
    s_cbranch_vccz L_nb_88
    s_waitcnt vmcnt(2)
L_nb_88:
    buffer_load_dwordx4 v[48:51], v1, s[36:39], s71 offen nt
    s_add_u32 s71, s71, 8192
    v_mfma_f32_16x16x32_bf16 v[16:19], v[24:27], v[52:55], v[16:19]
    v_and_b32_dpp v24, v42, v4 row_newbcast:1 row_mask:0xf bank_mask:0xf
    v_and_b32_dpp v25, v42, v5 row_newbcast:1 row_mask:0xf bank_mask:0xf
    v_and_b32_dpp v26, v42, v6 row_newbcast:1 row_mask:0xf bank_mask:0xf
    v_and_b32_dpp v27, v42, v7 row_newbcast:1 row_mask:0xf bank_mask:0xf
    s_waitcnt vmcnt(3)
    s_cbranch_vccz L_nb_89
    s_waitcnt vmcnt(2)
L_nb_89:
    buffer_load_dwordx4 v[52:55], v1, s[36:39], s71 offen nt
    s_add_u32 s71, s71, 8192
    v_mfma_f32_16x16x32_bf16 v[16:19], v[28:31], v[56:59], v[16:19]
    v_and_b32_dpp v28, v42, v4 row_newbcast:9 row_mask:0xf bank_mask:0xf
    v_and_b32_dpp v29, v42, v5 row_newbcast:9 row_mask:0xf bank_mask:0xf
    v_and_b32_dpp v30, v42, v6 row_newbcast:9 row_mask:0xf bank_mask:0xf
    v_and_b32_dpp v31, v42, v7 row_newbcast:9 row_mask:0xf bank_mask:0xf
    s_waitcnt vmcnt(3)
    s_cbranch_vccz L_nb_90
    s_waitcnt vmcnt(2)
L_nb_90:
    buffer_load_dwordx4 v[56:59], v1, s[36:39], s71 offen nt
    s_add_u32 s71, s71, 8192
    v_mfma_f32_16x16x32_bf16 v[16:19], v[24:27], v[60:63], v[16:19]
    v_and_b32_dpp v24, v42, v4 row_newbcast:5 row_mask:0xf bank_mask:0xf
    v_and_b32_dpp v25, v42, v5 row_newbcast:5 row_mask:0xf bank_mask:0xf
    v_and_b32_dpp v26, v42, v6 row_newbcast:5 row_mask:0xf bank_mask:0xf
    v_and_b32_dpp v27, v42, v7 row_newbcast:5 row_mask:0xf bank_mask:0xf
    s_waitcnt vmcnt(3)
    s_cbranch_vccz L_nb_91
    s_waitcnt vmcnt(2)
L_nb_91:
    buffer_load_dwordx4 v[60:63], v1, s[36:39], s71 offen nt
    s_add_u32 s71, s71, 8192
    v_mfma_f32_16x16x32_bf16 v[16:19], v[28:31], v[64:67], v[16:19]
    v_and_b32_dpp v28, v42, v4 row_newbcast:13 row_mask:0xf bank_mask:0xf
    v_and_b32_dpp v29, v42, v5 row_newbcast:13 row_mask:0xf bank_mask:0xf
    v_and_b32_dpp v30, v42, v6 row_newbcast:13 row_mask:0xf bank_mask:0xf
    v_and_b32_dpp v31, v42, v7 row_newbcast:13 row_mask:0xf bank_mask:0xf
    s_waitcnt vmcnt(3)
    s_cbranch_vccz L_nb_92
    s_waitcnt vmcnt(2)
L_nb_92:
    buffer_load_dwordx4 v[64:67], v1, s[36:39], s71 offen nt
    s_add_u32 s71, s71, 8192
    v_mfma_f32_16x16x32_bf16 v[16:19], v[24:27], v[48:51], v[16:19]
    v_and_b32_dpp v24, v42, v4 row_newbcast:3 row_mask:0xf bank_mask:0xf
    v_and_b32_dpp v25, v42, v5 row_newbcast:3 row_mask:0xf bank_mask:0xf
    v_and_b32_dpp v26, v42, v6 row_newbcast:3 row_mask:0xf bank_mask:0xf
    v_and_b32_dpp v27, v42, v7 row_newbcast:3 row_mask:0xf bank_mask:0xf
    s_waitcnt vmcnt(3)
    s_cbranch_vccz L_nb_93
    s_waitcnt vmcnt(2)
L_nb_93:
    buffer_load_dwordx4 v[48:51], v1, s[36:39], s71 offen nt
    s_add_u32 s71, s71, 8192
    v_mfma_f32_16x16x32_bf16 v[16:19], v[28:31], v[52:55], v[16:19]
    v_and_b32_dpp v28, v42, v4 row_newbcast:11 row_mask:0xf bank_mask:0xf
    v_and_b32_dpp v29, v42, v5 row_newbcast:11 row_mask:0xf bank_mask:0xf
    v_and_b32_dpp v30, v42, v6 row_newbcast:11 row_mask:0xf bank_mask:0xf
    v_and_b32_dpp v31, v42, v7 row_newbcast:11 row_mask:0xf bank_mask:0xf
    s_waitcnt vmcnt(3)
    s_cbranch_vccz L_nb_94
    s_waitcnt vmcnt(2)
L_nb_94:
    buffer_load_dwordx4 v[52:55], v1, s[36:39], s71 offen nt
    s_add_u32 s71, s71, 8192
    v_mfma_f32_16x16x32_bf16 v[16:19], v[24:27], v[56:59], v[16:19]
    v_and_b32_dpp v24, v42, v4 row_newbcast:7 row_mask:0xf bank_mask:0xf
    v_and_b32_dpp v25, v42, v5 row_newbcast:7 row_mask:0xf bank_mask:0xf
    v_and_b32_dpp v26, v42, v6 row_newbcast:7 row_mask:0xf bank_mask:0xf
    v_and_b32_dpp v27, v42, v7 row_newbcast:7 row_mask:0xf bank_mask:0xf
    s_waitcnt vmcnt(3)
    s_cbranch_vccz L_nb_95
    s_waitcnt vmcnt(2)
L_nb_95:
    buffer_load_dwordx4 v[56:59], v1, s[36:39], s71 offen nt
    s_add_u32 s71, s71, 8192
    v_mfma_f32_16x16x32_bf16 v[16:19], v[28:31], v[60:63], v[16:19]
    v_and_b32_dpp v28, v42, v4 row_newbcast:15 row_mask:0xf bank_mask:0xf
    v_and_b32_dpp v29, v42, v5 row_newbcast:15 row_mask:0xf bank_mask:0xf
    v_and_b32_dpp v30, v42, v6 row_newbcast:15 row_mask:0xf bank_mask:0xf
    v_and_b32_dpp v31, v42, v7 row_newbcast:15 row_mask:0xf bank_mask:0xf
    s_waitcnt vmcnt(3)
    s_cbranch_vccz L_nb_96
    s_waitcnt vmcnt(2)
L_nb_96:
    buffer_load_dwordx4 v[60:63], v1, s[36:39], s71 offen nt
    s_add_u32 s71, s71, 8192
    v_mfma_f32_16x16x32_bf16 v[16:19], v[24:27], v[64:67], v[16:19]
    v_and_b32_dpp v24, v43, v4 row_newbcast:0 row_mask:0xf bank_mask:0xf
    v_and_b32_dpp v25, v43, v5 row_newbcast:0 row_mask:0xf bank_mask:0xf
    v_and_b32_dpp v26, v43, v6 row_newbcast:0 row_mask:0xf bank_mask:0xf
    v_and_b32_dpp v27, v43, v7 row_newbcast:0 row_mask:0xf bank_mask:0xf
    s_waitcnt vmcnt(3)
    s_cbranch_vccz L_nb_97
    s_waitcnt vmcnt(2)
L_nb_97:
    buffer_load_dwordx4 v[64:67], v1, s[36:39], s71 offen nt
    s_add_u32 s71, s71, 8192
    v_mfma_f32_16x16x32_bf16 v[16:19], v[28:31], v[48:51], v[16:19]
    v_and_b32_dpp v28, v43, v4 row_newbcast:8 row_mask:0xf bank_mask:0xf
    v_and_b32_dpp v29, v43, v5 row_newbcast:8 row_mask:0xf bank_mask:0xf
    v_and_b32_dpp v30, v43, v6 row_newbcast:8 row_mask:0xf bank_mask:0xf
    v_and_b32_dpp v31, v43, v7 row_newbcast:8 row_mask:0xf bank_mask:0xf
    s_waitcnt vmcnt(3)
    s_cbranch_vccz L_nb_98
    s_waitcnt vmcnt(2)
L_nb_98:
    buffer_load_dwordx4 v[48:51], v1, s[36:39], s71 offen nt
    s_add_u32 s71, s71, 8192
    v_mfma_f32_16x16x32_bf16 v[16:19], v[24:27], v[52:55], v[16:19]
    v_and_b32_dpp v24, v43, v4 row_newbcast:4 row_mask:0xf bank_mask:0xf
    v_and_b32_dpp v25, v43, v5 row_newbcast:4 row_mask:0xf bank_mask:0xf
    v_and_b32_dpp v26, v43, v6 row_newbcast:4 row_mask:0xf bank_mask:0xf
    v_and_b32_dpp v27, v43, v7 row_newbcast:4 row_mask:0xf bank_mask:0xf
    s_waitcnt vmcnt(3)
    s_cbranch_vccz L_nb_99
    s_waitcnt vmcnt(2)
L_nb_99:
    buffer_load_dwordx4 v[52:55], v1, s[36:39], s71 offen nt
    s_add_u32 s71, s71, 8192
    v_mfma_f32_16x16x32_bf16 v[16:19], v[28:31], v[56:59], v[16:19]
    v_and_b32_dpp v28, v43, v4 row_newbcast:12 row_mask:0xf bank_mask:0xf
    v_and_b32_dpp v29, v43, v5 row_newbcast:12 row_mask:0xf bank_mask:0xf
    v_and_b32_dpp v30, v43, v6 row_newbcast:12 row_mask:0xf bank_mask:0xf
    v_and_b32_dpp v31, v43, v7 row_newbcast:12 row_mask:0xf bank_mask:0xf
    buffer_load_dwordx4 v[32:35], v44, s[60:63], s68 offen sc1
    s_waitcnt vmcnt(4)
    s_cbranch_vccz L_nb_100
    s_waitcnt vmcnt(3)
L_nb_100:
    buffer_load_dwordx4 v[56:59], v1, s[36:39], s71 offen nt
    s_add_u32 s71, s71, 8192
    v_mfma_f32_16x16x32_bf16 v[16:19], v[24:27], v[60:63], v[16:19]
    v_and_b32_dpp v24, v43, v4 row_newbcast:2 row_mask:0xf bank_mask:0xf
    v_and_b32_dpp v25, v43, v5 row_newbcast:2 row_mask:0xf bank_mask:0xf
    v_and_b32_dpp v26, v43, v6 row_newbcast:2 row_mask:0xf bank_mask:0xf
    v_and_b32_dpp v27, v43, v7 row_newbcast:2 row_mask:0xf bank_mask:0xf
    s_waitcnt vmcnt(4)
    s_cbranch_vccz L_nb_101
    s_waitcnt vmcnt(3)
L_nb_101:
    buffer_load_dwordx4 v[60:63], v1, s[36:39], s71 offen nt
    s_add_u32 s71, s71, 8192
    v_mfma_f32_16x16x32_bf16 v[16:19], v[28:31], v[64:67], v[16:19]
    v_and_b32_dpp v28, v43, v4 row_newbcast:10 row_mask:0xf bank_mask:0xf
    v_and_b32_dpp v29, v43, v5 row_newbcast:10 row_mask:0xf bank_mask:0xf
    v_and_b32_dpp v30, v43, v6 row_newbcast:10 row_mask:0xf bank_mask:0xf
    v_and_b32_dpp v31, v43, v7 row_newbcast:10 row_mask:0xf bank_mask:0xf
    s_waitcnt vmcnt(4)
    s_cbranch_vccz L_nb_102
    s_waitcnt vmcnt(3)
L_nb_102:
    buffer_load_dwordx4 v[64:67], v1, s[36:39], s71 offen nt
    s_add_u32 s71, s71, 8192
    v_mfma_f32_16x16x32_bf16 v[16:19], v[24:27], v[48:51], v[16:19]
    v_and_b32_dpp v24, v43, v4 row_newbcast:6 row_mask:0xf bank_mask:0xf
    v_and_b32_dpp v25, v43, v5 row_newbcast:6 row_mask:0xf bank_mask:0xf
    v_and_b32_dpp v26, v43, v6 row_newbcast:6 row_mask:0xf bank_mask:0xf
    v_and_b32_dpp v27, v43, v7 row_newbcast:6 row_mask:0xf bank_mask:0xf
    s_waitcnt vmcnt(4)
    s_cbranch_vccz L_nb_103
    s_waitcnt vmcnt(3)
L_nb_103:
    buffer_load_dwordx4 v[48:51], v1, s[36:39], s71 offen nt
    s_add_u32 s71, s71, 8192
    v_mfma_f32_16x16x32_bf16 v[16:19], v[28:31], v[52:55], v[16:19]
    v_and_b32_dpp v28, v43, v4 row_newbcast:14 row_mask:0xf bank_mask:0xf
    v_and_b32_dpp v29, v43, v5 row_newbcast:14 row_mask:0xf bank_mask:0xf
    v_and_b32_dpp v30, v43, v6 row_newbcast:14 row_mask:0xf bank_mask:0xf
    v_and_b32_dpp v31, v43, v7 row_newbcast:14 row_mask:0xf bank_mask:0xf
    s_waitcnt vmcnt(3)
    s_cbranch_vccz L_nb_104
    s_waitcnt vmcnt(2)
L_nb_104:
    buffer_load_dwordx4 v[52:55], v1, s[36:39], s71 offen nt
    s_add_u32 s71, s71, 8192
    v_mfma_f32_16x16x32_bf16 v[16:19], v[24:27], v[56:59], v[16:19]
    v_and_b32_dpp v24, v43, v4 row_newbcast:1 row_mask:0xf bank_mask:0xf
    v_and_b32_dpp v25, v43, v5 row_newbcast:1 row_mask:0xf bank_mask:0xf
    v_and_b32_dpp v26, v43, v6 row_newbcast:1 row_mask:0xf bank_mask:0xf
    v_and_b32_dpp v27, v43, v7 row_newbcast:1 row_mask:0xf bank_mask:0xf
    s_waitcnt vmcnt(3)
    s_cbranch_vccz L_nb_105
    s_waitcnt vmcnt(2)
L_nb_105:
    buffer_load_dwordx4 v[56:59], v1, s[36:39], s71 offen nt
    s_add_u32 s71, s71, 8192
    v_mfma_f32_16x16x32_bf16 v[16:19], v[28:31], v[60:63], v[16:19]
    v_and_b32_dpp v28, v43, v4 row_newbcast:9 row_mask:0xf bank_mask:0xf
    v_and_b32_dpp v29, v43, v5 row_newbcast:9 row_mask:0xf bank_mask:0xf
    v_and_b32_dpp v30, v43, v6 row_newbcast:9 row_mask:0xf bank_mask:0xf
    v_and_b32_dpp v31, v43, v7 row_newbcast:9 row_mask:0xf bank_mask:0xf
    s_waitcnt vmcnt(3)
    s_cbranch_vccz L_nb_106
    s_waitcnt vmcnt(2)
L_nb_106:
    buffer_load_dwordx4 v[60:63], v1, s[36:39], s71 offen nt
    s_add_u32 s71, s71, 8192
    v_mfma_f32_16x16x32_bf16 v[16:19], v[24:27], v[64:67], v[16:19]
    v_and_b32_dpp v24, v43, v4 row_newbcast:5 row_mask:0xf bank_mask:0xf
    v_and_b32_dpp v25, v43, v5 row_newbcast:5 row_mask:0xf bank_mask:0xf
    v_and_b32_dpp v26, v43, v6 row_newbcast:5 row_mask:0xf bank_mask:0xf
    v_and_b32_dpp v27, v43, v7 row_newbcast:5 row_mask:0xf bank_mask:0xf
    s_waitcnt vmcnt(3)
    s_cbranch_vccz L_nb_107
    s_waitcnt vmcnt(2)
L_nb_107:
    buffer_load_dwordx4 v[64:67], v1, s[36:39], s71 offen nt
    s_add_u32 s71, s71, 8192
    v_mfma_f32_16x16x32_bf16 v[16:19], v[28:31], v[48:51], v[16:19]
    s_mov_b32 s100, 1048576
L_ml_108:
    v_xor_b32 v34, s14, v34
    v_xor_b32 v35, s15, v35
    v_or_b32 v36, v34, v35
    v_cmp_ne_u32 vcc, 0, v36
    s_nop 1
    s_cbranch_vccz L_ml_108_ok
    s_sub_u32 s100, s100, 1
    s_cmp_eq_u32 s100, 0
    s_cbranch_scc1 L_ml_108_ok
    s_sleep 8
    buffer_load_dwordx4 v[32:35], v44, s[60:63], s68 offen sc1
    s_waitcnt vmcnt(0)
    s_branch L_ml_108
L_ml_108_ok:
    v_mov_b32 v36, v32
    s_nop 1
    v_max_f32_dpp v36, v36, v36 row_half_mirror row_mask:0xf bank_mask:0xf
    s_nop 1
    v_max_f32_dpp v36, v36, v36 quad_perm:[2,3,0,1] row_mask:0xf bank_mask:0xf
    s_nop 1
    v_max_f32_dpp v36, v36, v36 quad_perm:[1,0,3,2] row_mask:0xf bank_mask:0xf
    v_sub_f32 v37, v32, v36
    v_mul_f32 v37, 0x3fb8aa3b, v37
    v_exp_f32 v37, v37
    s_nop 0
    v_mul_f32 v37, v37, v33
    s_nop 1
    v_add_f32_dpp v37, v37, v37 row_half_mirror row_mask:0xf bank_mask:0xf
    s_nop 1
    v_add_f32_dpp v37, v37, v37 quad_perm:[2,3,0,1] row_mask:0xf bank_mask:0xf
    s_nop 1
    v_add_f32_dpp v37, v37, v37 quad_perm:[1,0,3,2] row_mask:0xf bank_mask:0xf
    v_rcp_f32 v37, v37
    v_sub_f32 v47, v40, v36
    v_mul_f32 v47, 0x3fb8aa3b, v47
    v_exp_f32 v47, v47
    s_nop 0
    v_mul_f32 v47, v47, v37
    v_and_b32 v44, 3, v45
    v_lshlrev_b32 v44, 7, v44
    v_lshrrev_b32 v32, 2, v45
    v_lshl_add_u32 v44, v32, 5, v44
    v_lshl_add_u32 v44, v46, 4, v44
    s_lshl_b32 s72, s3, 9
    v_add_u32 v44, s72, v44
    s_bitcmp0_b32 s2, 0
    s_cselect_b64 vcc, -1, 0
    v_and_b32_dpp v28, v43, v4 row_newbcast:13 row_mask:0xf bank_mask:0xf
    v_and_b32_dpp v29, v43, v5 row_newbcast:13 row_mask:0xf bank_mask:0xf
    v_and_b32_dpp v30, v43, v6 row_newbcast:13 row_mask:0xf bank_mask:0xf
    v_and_b32_dpp v31, v43, v7 row_newbcast:13 row_mask:0xf bank_mask:0xf
    s_waitcnt vmcnt(3)
    s_cbranch_vccz L_nb_109
    s_waitcnt vmcnt(2)
L_nb_109:
    buffer_load_dwordx4 v[48:51], v1, s[36:39], s71 offen nt
    s_add_u32 s71, s71, 8192
    v_mfma_f32_16x16x32_bf16 v[16:19], v[24:27], v[52:55], v[16:19]
    v_and_b32_dpp v24, v43, v4 row_newbcast:3 row_mask:0xf bank_mask:0xf
    v_and_b32_dpp v25, v43, v5 row_newbcast:3 row_mask:0xf bank_mask:0xf
    v_and_b32_dpp v26, v43, v6 row_newbcast:3 row_mask:0xf bank_mask:0xf
    v_and_b32_dpp v27, v43, v7 row_newbcast:3 row_mask:0xf bank_mask:0xf
    s_waitcnt vmcnt(3)
    s_cbranch_vccz L_nb_110
    s_waitcnt vmcnt(2)
L_nb_110:
    buffer_load_dwordx4 v[52:55], v1, s[36:39], s71 offen nt
    s_add_u32 s71, s71, 8192
    v_mov_b32 v32, 0
    v_mov_b32 v33, 1
    s_mov_b64 exec, 1
    ds_add_u32 v32, v33 offset:1616
    s_mov_b64 exec, -1
    v_mfma_f32_16x16x32_bf16 v[16:19], v[28:31], v[56:59], v[16:19]
    v_and_b32_dpp v28, v43, v4 row_newbcast:11 row_mask:0xf bank_mask:0xf
    v_and_b32_dpp v29, v43, v5 row_newbcast:11 row_mask:0xf bank_mask:0xf
    v_and_b32_dpp v30, v43, v6 row_newbcast:11 row_mask:0xf bank_mask:0xf
    v_and_b32_dpp v31, v43, v7 row_newbcast:11 row_mask:0xf bank_mask:0xf
    s_waitcnt vmcnt(3)
    v_mfma_f32_16x16x32_bf16 v[16:19], v[24:27], v[60:63], v[16:19]
    v_and_b32_dpp v24, v43, v4 row_newbcast:7 row_mask:0xf bank_mask:0xf
    v_and_b32_dpp v25, v43, v5 row_newbcast:7 row_mask:0xf bank_mask:0xf
    v_and_b32_dpp v26, v43, v6 row_newbcast:7 row_mask:0xf bank_mask:0xf
    v_and_b32_dpp v27, v43, v7 row_newbcast:7 row_mask:0xf bank_mask:0xf
    s_waitcnt vmcnt(2)
    v_mfma_f32_16x16x32_bf16 v[16:19], v[28:31], v[64:67], v[16:19]
    v_and_b32_dpp v28, v43, v4 row_newbcast:15 row_mask:0xf bank_mask:0xf
    v_and_b32_dpp v29, v43, v5 row_newbcast:15 row_mask:0xf bank_mask:0xf
    v_and_b32_dpp v30, v43, v6 row_newbcast:15 row_mask:0xf bank_mask:0xf
    v_and_b32_dpp v31, v43, v7 row_newbcast:15 row_mask:0xf bank_mask:0xf
    s_waitcnt vmcnt(1)
    v_mfma_f32_16x16x32_bf16 v[16:19], v[24:27], v[48:51], v[16:19]
    s_waitcnt vmcnt(0)
    v_mfma_f32_16x16x32_bf16 v[16:19], v[28:31], v[52:55], v[16:19]
    s_nop 7
    v_mul_f32 v16, v16, v47
    v_mul_f32 v17, v17, v47
    v_mul_f32 v18, v18, v47
    v_mul_f32 v19, v19, v47
    s_mov_b32 exec_lo, 0xffffffff
    s_mov_b32 exec_hi, 0x0
    ds_write_b128 v44, v[16:19] offset:4096
    s_mov_b64 exec, -1
    s_waitcnt lgkmcnt(0)
    s_barrier
L_fin:
L_end:
    s_endpgm
.section .rodata,"a"
.p2align 6
.amdhsa_kernel parallel_sum__mha_block_cached__glu_gated_reglu__decode_kernel
  .amdhsa_next_free_vgpr 168
  .amdhsa_next_free_sgpr 102
  .amdhsa_accum_offset 168
  .amdhsa_group_segment_fixed_size 0
  .amdhsa_kernarg_size 96
  .amdhsa_user_sgpr_count 2
  .amdhsa_user_sgpr_kernarg_segment_ptr 1
  .amdhsa_system_sgpr_workgroup_id_x 1
.end_amdhsa_kernel
```
